```python
import torch

def _softmax(x, axis=-1):
    return torch.softmax(x, dim=axis)
def _gelu(x):
    return torch.nn.functional.gelu(x, approximate="tanh")
def _silu(x):
    return torch.nn.functional.silu(x)
def _sigmoid(x):
    return torch.sigmoid(x)
def _layernorm(x, axis=-1, eps=1e-5):
    m = x.mean(dim=axis, keepdim=True)
    v = x.var(dim=axis, keepdim=True, unbiased=False)
    return (x - m) / torch.sqrt(v + eps)
def _scatter_add(tgt, idx, src, axis=0):
    return tgt.clone().index_add_(axis, idx, src)
def _segment_sum(src, seg, n):
    out = torch.zeros((n,) + src.shape[1:], dtype=src.dtype)
    return out.index_add_(0, seg, src)
def _pad(x, pw):
    flat = tuple(v for pair in reversed(pw) for v in pair)
    return torch.nn.functional.pad(x, flat)

kernel_name = 'standalone__gqa_softmax__near_ridge'

def setup_inputs():

    _w = (lambda a: (lambda t: t.to(torch.bfloat16) if t.is_floating_point() else t)(torch.as_tensor(a)))
    B, Hq, Hkv, Sq, Sk, D = 16, 32, 16, 288, 512, 128
    return {
        "q": _w((lambda *s: torch.randn(*s, dtype=torch.bfloat16) * 0.8)(B, Hq, Sq, D)),
        "k": _w((lambda *s: torch.randn(*s, dtype=torch.bfloat16) * 0.8)(B, Hkv, Sk, D)),
        "v": _w((lambda *s: torch.randn(*s, dtype=torch.bfloat16) * 0.05)(B, Hkv, Sk, D)),
    }

def reference(q, k, v):
    B, Hq, Sq, D = q.shape
    Hkv = k.shape[1]
    rep = Hq // Hkv
    k = (lambda x, n, axis: torch.repeat_interleave(x, n, dim=axis))(k, rep, axis=1)
    v = (lambda x, n, axis: torch.repeat_interleave(x, n, dim=axis))(v, rep, axis=1)
    scale = D ** -0.5
    scores = torch.einsum("bhqd,bhkd->bhqk", q, k) * scale
    p = _softmax(scores, axis=-1)
    return torch.einsum("bhqk,bhkd->bhqd", p, v)
```

```asm
; @launch grid=(256,1,1) block=(512,1,1) lds=145472
.amdgcn_target "amdgcn-amd-amdhsa--gfx950"
.text
.globl standalone__gqa_softmax__near_ridge_kernel
.p2align 8
.type standalone__gqa_softmax__near_ridge_kernel,@function
standalone__gqa_softmax__near_ridge_kernel:
    s_cmp_ge_u32 s2, 256
    s_cbranch_scc1 L_end
    s_load_dwordx8 s[4:11], s[0:1], 0
    v_lshrrev_b32 v1, 6, v0
    v_and_b32 v0, 63, v0
    s_mov_b32 s28, 0x3e0293ee
    v_readfirstlane_b32 s29, v1
    s_mul_i32 s32, s2, 147456
    s_lshl_b32 s33, s2, 17
    s_mov_b32 s42, 0
    s_mov_b32 s46, 0x8000
    s_mov_b32 s49, 0x100000
    s_movk_i32 s47, 0x2000
    v_mov_b32 v127, 0
    s_and_b32 s30, s29, 3
    s_waitcnt lgkmcnt(0)
    s_add_u32 s12, s4, s32
    s_addc_u32 s13, s5, 0
    s_mov_b32 s14, 147456
    s_mov_b32 s15, 0x20000
    s_add_u32 s16, s6, s33
    s_addc_u32 s17, s7, 0
    s_mov_b32 s18, 131072
    s_mov_b32 s19, 0x20000
    s_add_u32 s20, s8, s33
    s_addc_u32 s21, s9, 0
    s_mov_b32 s22, 131072
    s_mov_b32 s23, 0x20000
    s_add_u32 s24, s10, s32
    s_addc_u32 s25, s11, 0
    s_mov_b32 s26, 147456
    s_mov_b32 s27, 0x20000
    s_cmp_ge_u32 s29, 4
    s_cbranch_scc1 L_consumer
    s_lshl_b32 s32, s30, 15
    v_lshlrev_b32 v3, 4, v0
    v_add_u32 v4, s32, v3
    s_barrier
    s_movk_i32 s33, 24576
    s_movk_i32 s34, 28672
    buffer_load_dwordx4 a[96:99], v4, s[16:19], s33 offen offset:0 nt
    buffer_load_dwordx4 a[100:103], v4, s[16:19], s33 offen offset:1024 nt
    buffer_load_dwordx4 a[104:107], v4, s[16:19], s33 offen offset:2048 nt
    buffer_load_dwordx4 a[108:111], v4, s[16:19], s33 offen offset:3072 nt
    buffer_load_dwordx4 a[112:115], v4, s[16:19], s34 offen offset:0 nt
    buffer_load_dwordx4 a[116:119], v4, s[16:19], s34 offen offset:1024 nt
    buffer_load_dwordx4 a[120:123], v4, s[16:19], s34 offen offset:2048 nt
    buffer_load_dwordx4 a[124:127], v4, s[16:19], s34 offen offset:3072 nt
    s_movk_i32 s33, 0
    s_movk_i32 s34, 4096
    buffer_load_dwordx4 a[0:3], v4, s[16:19], s33 offen offset:0 nt
    buffer_load_dwordx4 a[4:7], v4, s[16:19], s33 offen offset:1024 nt
    buffer_load_dwordx4 a[8:11], v4, s[16:19], s33 offen offset:2048 nt
    buffer_load_dwordx4 a[12:15], v4, s[16:19], s33 offen offset:3072 nt
    buffer_load_dwordx4 a[16:19], v4, s[16:19], s34 offen offset:0 nt
    buffer_load_dwordx4 a[20:23], v4, s[16:19], s34 offen offset:1024 nt
    buffer_load_dwordx4 a[24:27], v4, s[16:19], s34 offen offset:2048 nt
    buffer_load_dwordx4 a[28:31], v4, s[16:19], s34 offen offset:3072 nt
    s_movk_i32 s33, 8192
    s_movk_i32 s34, 12288
    buffer_load_dwordx4 a[32:35], v4, s[16:19], s33 offen offset:0 nt
    buffer_load_dwordx4 a[36:39], v4, s[16:19], s33 offen offset:1024 nt
    buffer_load_dwordx4 a[40:43], v4, s[16:19], s33 offen offset:2048 nt
    buffer_load_dwordx4 a[44:47], v4, s[16:19], s33 offen offset:3072 nt
    buffer_load_dwordx4 a[48:51], v4, s[16:19], s34 offen offset:0 nt
    buffer_load_dwordx4 a[52:55], v4, s[16:19], s34 offen offset:1024 nt
    buffer_load_dwordx4 a[56:59], v4, s[16:19], s34 offen offset:2048 nt
    buffer_load_dwordx4 a[60:63], v4, s[16:19], s34 offen offset:3072 nt
    s_movk_i32 s33, 16384
    s_movk_i32 s34, 20480
    buffer_load_dwordx4 a[64:67], v4, s[16:19], s33 offen offset:0 nt
    buffer_load_dwordx4 a[68:71], v4, s[16:19], s33 offen offset:1024 nt
    buffer_load_dwordx4 a[72:75], v4, s[16:19], s33 offen offset:2048 nt
    buffer_load_dwordx4 a[76:79], v4, s[16:19], s33 offen offset:3072 nt
    buffer_load_dwordx4 a[80:83], v4, s[16:19], s34 offen offset:0 nt
    buffer_load_dwordx4 a[84:87], v4, s[16:19], s34 offen offset:1024 nt
    buffer_load_dwordx4 a[88:91], v4, s[16:19], s34 offen offset:2048 nt
    buffer_load_dwordx4 a[92:95], v4, s[16:19], s34 offen offset:3072 nt
    v_and_b32 v1, 31, v0
    v_lshrrev_b32 v2, 5, v0
    s_lshl_b32 s32, s30, 13
    v_add_u32 v114, s32, v3
    v_lshrrev_b32 v5, 4, v0
    v_and_b32 v6, 15, v0
    v_xor_b32 v6, v6, v5
    v_lshlrev_b32 v5, 8, v5
    v_add_u32 v5, s32, v5
    v_xor_b32 v7, 0, v6
    v_lshl_add_u32 v64, v7, 4, v5
    v_xor_b32 v7, 4, v6
    v_lshl_add_u32 v65, v7, 4, v5
    v_xor_b32 v7, 8, v6
    v_lshl_add_u32 v66, v7, 4, v5
    v_xor_b32 v7, 12, v6
    v_lshl_add_u32 v67, v7, 4, v5
    v_and_b32 v6, 15, v1
    v_xor_b32 v6, v6, v2
    v_lshlrev_b32 v5, 8, v1
    v_lshl_add_u32 v5, v6, 4, v5
    v_add_u32 v5, s32, v5
    v_xor_b32 v68, 0, v5
    v_xor_b32 v69, 32, v5
    v_xor_b32 v70, 64, v5
    v_xor_b32 v71, 96, v5
    v_xor_b32 v72, 128, v5
    v_xor_b32 v73, 160, v5
    v_xor_b32 v74, 192, v5
    v_xor_b32 v75, 224, v5
    v_lshrrev_b32 v5, 4, v1
    v_lshlrev_b32 v5, 12, v5
    v_and_b32 v6, 15, v1
    v_lshl_add_u32 v5, v6, 6, v5
    v_bfe_u32 v6, v1, 2, 2
    v_xor_b32 v6, v6, v2
    v_lshl_add_u32 v112, v6, 4, v5
    v_xor_b32 v6, 2, v6
    v_lshl_add_u32 v113, v6, 4, v5
    v_lshlrev_b32 v115, 5, v1
    v_lshl_add_u32 v115, v2, 2, v115
    s_lshl_b32 s32, s30, 3
    s_add_u32 s32, s32, 131072
    v_add_u32 v115, s32, v115
    v_and_b32 v124, 0xffffffe0, v115
    s_movk_i32 s36, 0x2000
    s_mov_b32 s43, 0
    s_barrier
    ds_read_b128 v[80:83], v112 offset:32768
    ds_read_b128 v[84:87], v113 offset:32768
    ds_read_b128 v[88:91], v112 offset:33792
    ds_read_b128 v[92:95], v113 offset:33792
    ds_read_b128 v[96:99], v112 offset:34816
    ds_read_b128 v[100:103], v113 offset:34816
    ds_read_b128 v[104:107], v112 offset:35840
    ds_read_b128 v[108:111], v113 offset:35840
    v_add_u32 v112, 106496, v112
    v_add_u32 v113, 106496, v113
    s_waitcnt vmcnt(31)
    ds_write_b128 v64, a[96:99] offset:0
    s_waitcnt vmcnt(30)
    ds_write_b128 v65, a[100:103] offset:1024
    s_waitcnt vmcnt(29)
    ds_write_b128 v66, a[104:107] offset:2048
    s_waitcnt vmcnt(28)
    ds_write_b128 v67, a[108:111] offset:3072
    s_waitcnt vmcnt(27)
    ds_write_b128 v64, a[112:115] offset:4096
    s_waitcnt vmcnt(26)
    ds_write_b128 v65, a[116:119] offset:5120
    s_waitcnt vmcnt(25)
    ds_write_b128 v66, a[120:123] offset:6144
    s_waitcnt vmcnt(24)
    ds_write_b128 v67, a[124:127] offset:7168
    ds_read_b128 a[96:99], v68 offset:0
    ds_read_b128 a[100:103], v69 offset:0
    ds_read_b128 a[104:107], v70 offset:0
    ds_read_b128 a[108:111], v71 offset:0
    ds_read_b128 a[112:115], v72 offset:0
    ds_read_b128 a[116:119], v73 offset:0
    ds_read_b128 a[120:123], v74 offset:0
    ds_read_b128 a[124:127], v75 offset:0
    s_waitcnt lgkmcnt(7)
    v_mfma_f32_32x32x16_bf16 v[48:63], a[96:99], v[80:83], 0
    s_waitcnt lgkmcnt(6)
    v_mfma_f32_32x32x16_bf16 v[48:63], a[100:103], v[84:87], v[48:63]
    s_waitcnt lgkmcnt(5)
    v_mfma_f32_32x32x16_bf16 v[48:63], a[104:107], v[88:91], v[48:63]
    s_waitcnt lgkmcnt(4)
    v_mfma_f32_32x32x16_bf16 v[48:63], a[108:111], v[92:95], v[48:63]
    s_waitcnt lgkmcnt(3)
    v_mfma_f32_32x32x16_bf16 v[48:63], a[112:115], v[96:99], v[48:63]
    s_waitcnt lgkmcnt(2)
    v_mfma_f32_32x32x16_bf16 v[48:63], a[116:119], v[100:103], v[48:63]
    s_waitcnt lgkmcnt(1)
    v_mfma_f32_32x32x16_bf16 v[48:63], a[120:123], v[104:107], v[48:63]
    s_waitcnt lgkmcnt(0)
    v_mfma_f32_32x32x16_bf16 v[48:63], a[124:127], v[108:111], v[48:63]
    s_waitcnt vmcnt(23)
    ds_write_b128 v64, a[0:3] offset:0
    s_waitcnt vmcnt(22)
    ds_write_b128 v65, a[4:7] offset:1024
    s_waitcnt vmcnt(21)
    ds_write_b128 v66, a[8:11] offset:2048
    s_waitcnt vmcnt(20)
    ds_write_b128 v67, a[12:15] offset:3072
    s_waitcnt vmcnt(19)
    ds_write_b128 v64, a[16:19] offset:4096
    s_waitcnt vmcnt(18)
    ds_write_b128 v65, a[20:23] offset:5120
    s_waitcnt vmcnt(17)
    ds_write_b128 v66, a[24:27] offset:6144
    s_waitcnt vmcnt(16)
    ds_write_b128 v67, a[28:31] offset:7168
    ds_read_b128 a[0:3], v68 offset:0
    ds_read_b128 a[4:7], v69 offset:0
    ds_read_b128 a[8:11], v70 offset:0
    ds_read_b128 a[12:15], v71 offset:0
    ds_read_b128 a[16:19], v72 offset:0
    ds_read_b128 a[20:23], v73 offset:0
    ds_read_b128 a[24:27], v74 offset:0
    ds_read_b128 a[28:31], v75 offset:0
    v_max3_f32 v116, v48, v49, v50
    v_max3_f32 v117, v51, v52, v53
    v_max3_f32 v116, v116, v54, v55
    v_max3_f32 v117, v117, v56, v57
    v_max3_f32 v116, v116, v58, v59
    v_max3_f32 v117, v117, v60, v61
    v_max3_f32 v116, v116, v62, v63
    s_waitcnt lgkmcnt(7)
    v_mfma_f32_32x32x16_bf16 v[0:15], a[0:3], v[80:83], 0
    s_waitcnt lgkmcnt(6)
    v_mfma_f32_32x32x16_bf16 v[0:15], a[4:7], v[84:87], v[0:15]
    s_waitcnt lgkmcnt(5)
    v_mfma_f32_32x32x16_bf16 v[0:15], a[8:11], v[88:91], v[0:15]
    s_waitcnt lgkmcnt(4)
    v_mfma_f32_32x32x16_bf16 v[0:15], a[12:15], v[92:95], v[0:15]
    s_waitcnt lgkmcnt(3)
    v_mfma_f32_32x32x16_bf16 v[0:15], a[16:19], v[96:99], v[0:15]
    s_waitcnt lgkmcnt(2)
    v_mfma_f32_32x32x16_bf16 v[0:15], a[20:23], v[100:103], v[0:15]
    s_waitcnt lgkmcnt(1)
    v_mfma_f32_32x32x16_bf16 v[0:15], a[24:27], v[104:107], v[0:15]
    s_waitcnt lgkmcnt(0)
    v_mfma_f32_32x32x16_bf16 v[0:15], a[28:31], v[108:111], v[0:15]
    s_waitcnt vmcnt(15)
    ds_write_b128 v64, a[32:35] offset:0
    s_waitcnt vmcnt(14)
    ds_write_b128 v65, a[36:39] offset:1024
    s_waitcnt vmcnt(13)
    ds_write_b128 v66, a[40:43] offset:2048
    s_waitcnt vmcnt(12)
    ds_write_b128 v67, a[44:47] offset:3072
    s_waitcnt vmcnt(11)
    ds_write_b128 v64, a[48:51] offset:4096
    s_waitcnt vmcnt(10)
    ds_write_b128 v65, a[52:55] offset:5120
    s_waitcnt vmcnt(9)
    ds_write_b128 v66, a[56:59] offset:6144
    s_waitcnt vmcnt(8)
    ds_write_b128 v67, a[60:63] offset:7168
    ds_read_b128 a[32:35], v68 offset:0
    ds_read_b128 a[36:39], v69 offset:0
    ds_read_b128 a[40:43], v70 offset:0
    ds_read_b128 a[44:47], v71 offset:0
    ds_read_b128 a[48:51], v72 offset:0
    ds_read_b128 a[52:55], v73 offset:0
    ds_read_b128 a[56:59], v74 offset:0
    ds_read_b128 a[60:63], v75 offset:0
    v_max3_f32 v116, v116, v0, v1
    v_max3_f32 v117, v117, v2, v3
    v_max3_f32 v116, v116, v4, v5
    v_max3_f32 v117, v117, v6, v7
    v_max3_f32 v116, v116, v8, v9
    v_max3_f32 v117, v117, v10, v11
    v_max3_f32 v116, v116, v12, v13
    v_max3_f32 v117, v117, v14, v15
    s_waitcnt lgkmcnt(7)
    v_mfma_f32_32x32x16_bf16 v[16:31], a[32:35], v[80:83], 0
    s_waitcnt lgkmcnt(6)
    v_mfma_f32_32x32x16_bf16 v[16:31], a[36:39], v[84:87], v[16:31]
    s_waitcnt lgkmcnt(5)
    v_mfma_f32_32x32x16_bf16 v[16:31], a[40:43], v[88:91], v[16:31]
    s_waitcnt lgkmcnt(4)
    v_mfma_f32_32x32x16_bf16 v[16:31], a[44:47], v[92:95], v[16:31]
    s_waitcnt lgkmcnt(3)
    v_mfma_f32_32x32x16_bf16 v[16:31], a[48:51], v[96:99], v[16:31]
    s_waitcnt lgkmcnt(2)
    v_mfma_f32_32x32x16_bf16 v[16:31], a[52:55], v[100:103], v[16:31]
    s_waitcnt lgkmcnt(1)
    v_mfma_f32_32x32x16_bf16 v[16:31], a[56:59], v[104:107], v[16:31]
    s_waitcnt lgkmcnt(0)
    v_mfma_f32_32x32x16_bf16 v[16:31], a[60:63], v[108:111], v[16:31]
    s_waitcnt vmcnt(7)
    ds_write_b128 v64, a[64:67] offset:0
    s_waitcnt vmcnt(6)
    ds_write_b128 v65, a[68:71] offset:1024
    s_waitcnt vmcnt(5)
    ds_write_b128 v66, a[72:75] offset:2048
    s_waitcnt vmcnt(4)
    ds_write_b128 v67, a[76:79] offset:3072
    s_waitcnt vmcnt(3)
    ds_write_b128 v64, a[80:83] offset:4096
    s_waitcnt vmcnt(2)
    ds_write_b128 v65, a[84:87] offset:5120
    s_waitcnt vmcnt(1)
    ds_write_b128 v66, a[88:91] offset:6144
    s_waitcnt vmcnt(0)
    ds_write_b128 v67, a[92:95] offset:7168
    ds_read_b128 a[64:67], v68 offset:0
    ds_read_b128 a[68:71], v69 offset:0
    ds_read_b128 a[72:75], v70 offset:0
    ds_read_b128 a[76:79], v71 offset:0
    ds_read_b128 a[80:83], v72 offset:0
    ds_read_b128 a[84:87], v73 offset:0
    ds_read_b128 a[88:91], v74 offset:0
    ds_read_b128 a[92:95], v75 offset:0
    v_max3_f32 v116, v116, v16, v17
    v_max3_f32 v117, v117, v18, v19
    v_max3_f32 v116, v116, v20, v21
    v_max3_f32 v117, v117, v22, v23
    v_max3_f32 v116, v116, v24, v25
    v_max3_f32 v117, v117, v26, v27
    v_max3_f32 v116, v116, v28, v29
    v_max3_f32 v117, v117, v30, v31
    s_waitcnt lgkmcnt(7)
    v_mfma_f32_32x32x16_bf16 v[32:47], a[64:67], v[80:83], 0
    ds_read_b128 v[80:83], v112 offset:0
    s_waitcnt lgkmcnt(7)
    v_mfma_f32_32x32x16_bf16 v[32:47], a[68:71], v[84:87], v[32:47]
    ds_read_b128 v[84:87], v113 offset:0
    s_waitcnt lgkmcnt(7)
    v_mfma_f32_32x32x16_bf16 v[32:47], a[72:75], v[88:91], v[32:47]
    ds_read_b128 v[88:91], v112 offset:1024
    s_waitcnt lgkmcnt(7)
    v_mfma_f32_32x32x16_bf16 v[32:47], a[76:79], v[92:95], v[32:47]
    ds_read_b128 v[92:95], v113 offset:1024
    s_waitcnt lgkmcnt(7)
    v_mfma_f32_32x32x16_bf16 v[32:47], a[80:83], v[96:99], v[32:47]
    ds_read_b128 v[96:99], v112 offset:2048
    s_waitcnt lgkmcnt(7)
    v_mfma_f32_32x32x16_bf16 v[32:47], a[84:87], v[100:103], v[32:47]
    ds_read_b128 v[100:103], v113 offset:2048
    s_waitcnt lgkmcnt(7)
    v_mfma_f32_32x32x16_bf16 v[32:47], a[88:91], v[104:107], v[32:47]
    ds_read_b128 v[104:107], v112 offset:3072
    s_waitcnt lgkmcnt(7)
    v_mfma_f32_32x32x16_bf16 v[32:47], a[92:95], v[108:111], v[32:47]
    ds_read_b128 v[108:111], v113 offset:3072
    s_nop 10
    v_max3_f32 v116, v116, v32, v33
    v_max3_f32 v117, v117, v34, v35
    v_max3_f32 v116, v116, v36, v37
    v_max3_f32 v117, v117, v38, v39
    v_max3_f32 v116, v116, v40, v41
    v_max3_f32 v117, v117, v42, v43
    v_max3_f32 v116, v116, v44, v45
    v_max3_f32 v117, v117, v46, v47
    v_max_f32 v116, v116, v117
    ds_write_b32 v115, v116 offset:2048
    v_mov_b32 v123, 145408
    v_mov_b32 v121, 1
    ds_add_u32 v123, v121 offset:0
L_psync0:
    ds_read_b32 v121, v123 offset:0
    s_waitcnt lgkmcnt(0)
    v_readfirstlane_b32 s32, v121
    s_sub_u32 s49, s49, 1
    s_cselect_b32 s32, 256, s32
    s_cmp_lt_u32 s32, 256
    s_cbranch_scc1 L_psync0
    ds_read_b128 v[120:123], v124 offset:2064
    ds_read_b128 v[116:119], v124 offset:2048
    s_waitcnt lgkmcnt(1)
    v_max3_f32 v120, v120, v121, v122
    s_waitcnt lgkmcnt(0)
    v_max3_f32 v116, v116, v117, v118
    v_max3_f32 v120, v120, v123, v119
    v_max_f32 v116, v116, v120
    v_mul_f32 v120, s28, v116
    v_fma_f32 v0, v0, s28, -v120
    v_fma_f32 v1, v1, s28, -v120
    v_fma_f32 v2, v2, s28, -v120
    v_fma_f32 v3, v3, s28, -v120
    v_exp_f32 v0, v0
    v_exp_f32 v1, v1
    v_mfma_f32_32x32x16_bf16 v[64:79], a[96:99], v[80:83], 0
    v_fma_f32 v4, v4, s28, -v120
    v_fma_f32 v5, v5, s28, -v120
    v_exp_f32 v2, v2
    v_exp_f32 v3, v3
    v_mov_b32 v125, v0
    v_mov_b32 v126, v1
    v_cvt_pk_bf16_f32 v0, v0, v1
    v_mfma_f32_32x32x16_bf16 v[64:79], a[100:103], v[84:87], v[64:79]
    v_fma_f32 v6, v6, s28, -v120
    v_fma_f32 v7, v7, s28, -v120
    v_exp_f32 v4, v4
    v_exp_f32 v5, v5
    v_add_f32 v125, v125, v2
    v_add_f32 v126, v126, v3
    v_cvt_pk_bf16_f32 v1, v2, v3
    s_add_u32 s36, s36, s47
    s_cmp_eq_u32 s36, 0x8000
    s_cselect_b32 s44, 0xffffa000, s47
    s_cselect_b32 s36, 0, s36
    v_add_u32 v112, s44, v112
    v_add_u32 v113, s44, v113
    v_mfma_f32_32x32x16_bf16 v[64:79], a[104:107], v[88:91], v[64:79]
    v_fma_f32 v8, v8, s28, -v120
    v_fma_f32 v9, v9, s28, -v120
    v_exp_f32 v6, v6
    v_exp_f32 v7, v7
    v_add_f32 v125, v125, v4
    v_add_f32 v126, v126, v5
    v_cvt_pk_bf16_f32 v2, v4, v5
    v_mfma_f32_32x32x16_bf16 v[64:79], a[108:111], v[92:95], v[64:79]
    v_fma_f32 v10, v10, s28, -v120
    v_fma_f32 v11, v11, s28, -v120
    v_exp_f32 v8, v8
    v_exp_f32 v9, v9
    v_add_f32 v125, v125, v6
    v_add_f32 v126, v126, v7
    v_cvt_pk_bf16_f32 v3, v6, v7
    v_mfma_f32_32x32x16_bf16 v[64:79], a[112:115], v[96:99], v[64:79]
    ds_write_b128 v114, v[0:3] offset:0
    v_fma_f32 v12, v12, s28, -v120
    v_fma_f32 v13, v13, s28, -v120
    v_exp_f32 v10, v10
    v_exp_f32 v11, v11
    v_add_f32 v125, v125, v8
    v_add_f32 v126, v126, v9
    v_cvt_pk_bf16_f32 v8, v8, v9
    v_mfma_f32_32x32x16_bf16 v[64:79], a[116:119], v[100:103], v[64:79]
    v_fma_f32 v14, v14, s28, -v120
    v_fma_f32 v15, v15, s28, -v120
    v_exp_f32 v12, v12
    v_exp_f32 v13, v13
    v_add_f32 v125, v125, v10
    v_add_f32 v126, v126, v11
    v_cvt_pk_bf16_f32 v9, v10, v11
    v_mfma_f32_32x32x16_bf16 v[64:79], a[120:123], v[104:107], v[64:79]
    v_fma_f32 v16, v16, s28, -v120
    v_fma_f32 v17, v17, s28, -v120
    v_exp_f32 v14, v14
    v_exp_f32 v15, v15
    v_add_f32 v125, v125, v12
    v_add_f32 v126, v126, v13
    v_cvt_pk_bf16_f32 v10, v12, v13
    v_mfma_f32_32x32x16_bf16 v[64:79], a[124:127], v[108:111], v[64:79]
    v_fma_f32 v18, v18, s28, -v120
    v_fma_f32 v19, v19, s28, -v120
    v_exp_f32 v16, v16
    v_exp_f32 v17, v17
    v_add_f32 v125, v125, v14
    v_add_f32 v126, v126, v15
    v_cvt_pk_bf16_f32 v11, v14, v15
    ds_write_b128 v114, v[8:11] offset:1024
    v_fma_f32 v20, v20, s28, -v120
    v_fma_f32 v21, v21, s28, -v120
    v_exp_f32 v18, v18
    v_exp_f32 v19, v19
    v_add_f32 v125, v125, v16
    v_add_f32 v126, v126, v17
    v_cvt_pk_bf16_f32 v16, v16, v17
    v_mfma_f32_32x32x16_bf16 v[0:15], a[0:3], v[80:83], 0
    v_fma_f32 v22, v22, s28, -v120
    v_fma_f32 v23, v23, s28, -v120
    v_exp_f32 v20, v20
    v_exp_f32 v21, v21
    v_add_f32 v125, v125, v18
    v_add_f32 v126, v126, v19
    v_cvt_pk_bf16_f32 v17, v18, v19
    v_max3_f32 v116, v64, v65, v66
    v_mfma_f32_32x32x16_bf16 v[0:15], a[4:7], v[84:87], v[0:15]
    v_fma_f32 v24, v24, s28, -v120
    v_fma_f32 v25, v25, s28, -v120
    v_exp_f32 v22, v22
    v_exp_f32 v23, v23
    v_add_f32 v125, v125, v20
    v_add_f32 v126, v126, v21
    v_cvt_pk_bf16_f32 v18, v20, v21
    v_max3_f32 v117, v67, v68, v69
    v_mfma_f32_32x32x16_bf16 v[0:15], a[8:11], v[88:91], v[0:15]
    v_fma_f32 v26, v26, s28, -v120
    v_fma_f32 v27, v27, s28, -v120
    v_exp_f32 v24, v24
    v_exp_f32 v25, v25
    v_add_f32 v125, v125, v22
    v_add_f32 v126, v126, v23
    v_cvt_pk_bf16_f32 v19, v22, v23
    v_max3_f32 v116, v116, v70, v71
    v_mfma_f32_32x32x16_bf16 v[0:15], a[12:15], v[92:95], v[0:15]
    ds_write_b128 v114, v[16:19] offset:2048
    v_fma_f32 v28, v28, s28, -v120
    v_fma_f32 v29, v29, s28, -v120
    v_exp_f32 v26, v26
    v_exp_f32 v27, v27
    v_add_f32 v125, v125, v24
    v_add_f32 v126, v126, v25
    v_cvt_pk_bf16_f32 v24, v24, v25
    v_max3_f32 v117, v117, v72, v73
    v_mfma_f32_32x32x16_bf16 v[0:15], a[16:19], v[96:99], v[0:15]
    v_fma_f32 v30, v30, s28, -v120
    v_fma_f32 v31, v31, s28, -v120
    v_exp_f32 v28, v28
    v_exp_f32 v29, v29
    v_add_f32 v125, v125, v26
    v_add_f32 v126, v126, v27
    v_cvt_pk_bf16_f32 v25, v26, v27
    v_max3_f32 v116, v116, v74, v75
    v_mfma_f32_32x32x16_bf16 v[0:15], a[20:23], v[100:103], v[0:15]
    v_fma_f32 v32, v32, s28, -v120
    v_fma_f32 v33, v33, s28, -v120
    v_exp_f32 v30, v30
    v_exp_f32 v31, v31
    v_add_f32 v125, v125, v28
    v_add_f32 v126, v126, v29
    v_cvt_pk_bf16_f32 v26, v28, v29
    v_max3_f32 v117, v117, v76, v77
    v_mfma_f32_32x32x16_bf16 v[0:15], a[24:27], v[104:107], v[0:15]
    v_fma_f32 v34, v34, s28, -v120
    v_fma_f32 v35, v35, s28, -v120
    v_exp_f32 v32, v32
    v_exp_f32 v33, v33
    v_add_f32 v125, v125, v30
    v_add_f32 v126, v126, v31
    v_cvt_pk_bf16_f32 v27, v30, v31
    v_max3_f32 v116, v116, v78, v79
    v_mfma_f32_32x32x16_bf16 v[0:15], a[28:31], v[108:111], v[0:15]
    ds_write_b128 v114, v[24:27] offset:3072
    v_fma_f32 v36, v36, s28, -v120
    v_fma_f32 v37, v37, s28, -v120
    v_exp_f32 v34, v34
    v_exp_f32 v35, v35
    v_add_f32 v125, v125, v32
    v_add_f32 v126, v126, v33
    v_cvt_pk_bf16_f32 v32, v32, v33
    v_mfma_f32_32x32x16_bf16 v[16:31], a[32:35], v[80:83], 0
    v_fma_f32 v38, v38, s28, -v120
    v_fma_f32 v39, v39, s28, -v120
    v_exp_f32 v36, v36
    v_exp_f32 v37, v37
    v_add_f32 v125, v125, v34
    v_add_f32 v126, v126, v35
    v_cvt_pk_bf16_f32 v33, v34, v35
    v_mfma_f32_32x32x16_bf16 v[16:31], a[36:39], v[84:87], v[16:31]
    v_fma_f32 v40, v40, s28, -v120
    v_fma_f32 v41, v41, s28, -v120
    v_exp_f32 v38, v38
    v_exp_f32 v39, v39
    v_add_f32 v125, v125, v36
    v_add_f32 v126, v126, v37
    v_cvt_pk_bf16_f32 v34, v36, v37
    v_max3_f32 v116, v116, v0, v1
    v_mfma_f32_32x32x16_bf16 v[16:31], a[40:43], v[88:91], v[16:31]
    v_fma_f32 v42, v42, s28, -v120
    v_fma_f32 v43, v43, s28, -v120
    v_exp_f32 v40, v40
    v_exp_f32 v41, v41
    v_add_f32 v125, v125, v38
    v_add_f32 v126, v126, v39
    v_cvt_pk_bf16_f32 v35, v38, v39
    v_max3_f32 v117, v117, v2, v3
    v_mfma_f32_32x32x16_bf16 v[16:31], a[44:47], v[92:95], v[16:31]
    ds_write_b128 v114, v[32:35] offset:4096
    v_fma_f32 v44, v44, s28, -v120
    v_fma_f32 v45, v45, s28, -v120
    v_exp_f32 v42, v42
    v_exp_f32 v43, v43
    v_add_f32 v125, v125, v40
    v_add_f32 v126, v126, v41
    v_cvt_pk_bf16_f32 v40, v40, v41
    v_max3_f32 v116, v116, v4, v5
    v_mfma_f32_32x32x16_bf16 v[16:31], a[48:51], v[96:99], v[16:31]
    v_fma_f32 v46, v46, s28, -v120
    v_fma_f32 v47, v47, s28, -v120
    v_exp_f32 v44, v44
    v_exp_f32 v45, v45
    v_add_f32 v125, v125, v42
    v_add_f32 v126, v126, v43
    v_cvt_pk_bf16_f32 v41, v42, v43
    v_max3_f32 v117, v117, v6, v7
    v_mfma_f32_32x32x16_bf16 v[16:31], a[52:55], v[100:103], v[16:31]
    v_fma_f32 v48, v48, s28, -v120
    v_fma_f32 v49, v49, s28, -v120
    v_exp_f32 v46, v46
    v_exp_f32 v47, v47
    v_add_f32 v125, v125, v44
    v_add_f32 v126, v126, v45
    v_cvt_pk_bf16_f32 v42, v44, v45
    v_max3_f32 v116, v116, v8, v9
    v_mfma_f32_32x32x16_bf16 v[16:31], a[56:59], v[104:107], v[16:31]
    v_fma_f32 v50, v50, s28, -v120
    v_fma_f32 v51, v51, s28, -v120
    v_exp_f32 v48, v48
    v_exp_f32 v49, v49
    v_add_f32 v125, v125, v46
    v_add_f32 v126, v126, v47
    v_cvt_pk_bf16_f32 v43, v46, v47
    v_max3_f32 v117, v117, v10, v11
    v_mfma_f32_32x32x16_bf16 v[16:31], a[60:63], v[108:111], v[16:31]
    ds_write_b128 v114, v[40:43] offset:5120
    v_fma_f32 v52, v52, s28, -v120
    v_fma_f32 v53, v53, s28, -v120
    v_exp_f32 v50, v50
    v_exp_f32 v51, v51
    v_add_f32 v125, v125, v48
    v_add_f32 v126, v126, v49
    v_cvt_pk_bf16_f32 v48, v48, v49
    v_max3_f32 v116, v116, v12, v13
    v_mfma_f32_32x32x16_bf16 v[32:47], a[64:67], v[80:83], 0
    ds_read_b128 v[80:83], v112 offset:0
    v_fma_f32 v54, v54, s28, -v120
    v_fma_f32 v55, v55, s28, -v120
    v_exp_f32 v52, v52
    v_exp_f32 v53, v53
    v_mfma_f32_32x32x16_bf16 v[32:47], a[68:71], v[84:87], v[32:47]
    ds_read_b128 v[84:87], v113 offset:0
    v_add_f32 v125, v125, v50
    v_add_f32 v126, v126, v51
    v_cvt_pk_bf16_f32 v49, v50, v51
    v_max3_f32 v117, v117, v14, v15
    v_mfma_f32_32x32x16_bf16 v[32:47], a[72:75], v[88:91], v[32:47]
    ds_read_b128 v[88:91], v112 offset:1024
    v_fma_f32 v56, v56, s28, -v120
    v_fma_f32 v57, v57, s28, -v120
    v_exp_f32 v54, v54
    v_exp_f32 v55, v55
    v_mfma_f32_32x32x16_bf16 v[32:47], a[76:79], v[92:95], v[32:47]
    ds_read_b128 v[92:95], v113 offset:1024
    v_add_f32 v125, v125, v52
    v_add_f32 v126, v126, v53
    v_cvt_pk_bf16_f32 v50, v52, v53
    v_max3_f32 v116, v116, v16, v17
    v_max3_f32 v117, v117, v18, v19
    v_mfma_f32_32x32x16_bf16 v[32:47], a[80:83], v[96:99], v[32:47]
    ds_read_b128 v[96:99], v112 offset:2048
    v_fma_f32 v58, v58, s28, -v120
    v_fma_f32 v59, v59, s28, -v120
    v_exp_f32 v56, v56
    v_exp_f32 v57, v57
    v_mfma_f32_32x32x16_bf16 v[32:47], a[84:87], v[100:103], v[32:47]
    ds_read_b128 v[100:103], v113 offset:2048
    v_add_f32 v125, v125, v54
    v_add_f32 v126, v126, v55
    v_cvt_pk_bf16_f32 v51, v54, v55
    v_max3_f32 v116, v116, v20, v21
    v_max3_f32 v117, v117, v22, v23
    v_mfma_f32_32x32x16_bf16 v[32:47], a[88:91], v[104:107], v[32:47]
    ds_read_b128 v[104:107], v112 offset:3072
    ds_write_b128 v114, v[48:51] offset:6144
    v_fma_f32 v60, v60, s28, -v120
    v_fma_f32 v61, v61, s28, -v120
    v_exp_f32 v58, v58
    v_exp_f32 v59, v59
    v_mfma_f32_32x32x16_bf16 v[32:47], a[92:95], v[108:111], v[32:47]
    ds_read_b128 v[108:111], v113 offset:3072
    v_add_f32 v125, v125, v56
    v_add_f32 v126, v126, v57
    v_cvt_pk_bf16_f32 v56, v56, v57
    v_max3_f32 v116, v116, v24, v25
    v_max3_f32 v117, v117, v26, v27
    v_fma_f32 v62, v62, s28, -v120
    v_fma_f32 v63, v63, s28, -v120
    v_exp_f32 v60, v60
    v_exp_f32 v61, v61
    v_add_f32 v125, v125, v58
    v_add_f32 v126, v126, v59
    v_cvt_pk_bf16_f32 v57, v58, v59
    v_max3_f32 v116, v116, v28, v29
    v_max3_f32 v117, v117, v30, v31
    v_exp_f32 v62, v62
    v_exp_f32 v63, v63
    v_add_f32 v125, v125, v60
    v_add_f32 v126, v126, v61
    v_cvt_pk_bf16_f32 v58, v60, v61
    v_max3_f32 v116, v116, v32, v33
    v_max3_f32 v117, v117, v34, v35
    v_max3_f32 v116, v116, v36, v37
    v_max3_f32 v117, v117, v38, v39
    v_max3_f32 v116, v116, v40, v41
    v_max3_f32 v117, v117, v42, v43
    v_max3_f32 v116, v116, v44, v45
    v_max3_f32 v117, v117, v46, v47
    v_max_f32 v116, v116, v117
    ds_write_b32 v115, v116 offset:3072
    v_mov_b32 v123, 145408
    v_mov_b32 v121, 1
    ds_add_u32 v123, v121 offset:4
L_psync1:
    ds_read_b32 v121, v123 offset:4
    s_waitcnt lgkmcnt(0)
    v_readfirstlane_b32 s32, v121
    s_sub_u32 s49, s49, 1
    s_cselect_b32 s32, 256, s32
    s_cmp_lt_u32 s32, 256
    s_cbranch_scc1 L_psync1
    ds_read_b128 v[120:123], v124 offset:3088
    ds_read_b128 v[116:119], v124 offset:3072
    v_add_f32 v125, v125, v62
    v_add_f32 v126, v126, v63
    v_cvt_pk_bf16_f32 v59, v62, v63
    ds_write_b128 v114, v[56:59] offset:7168
    v_add_f32 v125, v125, v126
    ds_write_b32 v115, v125 offset:0
    s_add_u32 s43, s43, s46
    s_cmp_eq_u32 s43, 0x18000
    s_cselect_b32 s44, 0xffff0000, s46
    s_cselect_b32 s43, 0, s43
    v_add_u32 v114, s44, v114
    s_waitcnt lgkmcnt(3)
    v_max3_f32 v120, v120, v121, v122
    s_waitcnt lgkmcnt(2)
    v_max3_f32 v116, v116, v117, v118
    v_max3_f32 v120, v120, v123, v119
    v_max_f32 v116, v116, v120
    v_mul_f32 v120, s28, v116
    v_fma_f32 v0, v0, s28, -v120
    v_fma_f32 v1, v1, s28, -v120
    v_fma_f32 v2, v2, s28, -v120
    v_fma_f32 v3, v3, s28, -v120
    v_exp_f32 v0, v0
    v_exp_f32 v1, v1
    v_mfma_f32_32x32x16_bf16 v[48:63], a[96:99], v[80:83], 0
    v_fma_f32 v4, v4, s28, -v120
    v_fma_f32 v5, v5, s28, -v120
    v_exp_f32 v2, v2
    v_exp_f32 v3, v3
    v_mov_b32 v125, v0
    v_mov_b32 v126, v1
    v_cvt_pk_bf16_f32 v0, v0, v1
    v_mfma_f32_32x32x16_bf16 v[48:63], a[100:103], v[84:87], v[48:63]
    v_fma_f32 v6, v6, s28, -v120
    v_fma_f32 v7, v7, s28, -v120
    v_exp_f32 v4, v4
    v_exp_f32 v5, v5
    v_add_f32 v125, v125, v2
    v_add_f32 v126, v126, v3
    v_cvt_pk_bf16_f32 v1, v2, v3
    s_add_u32 s36, s36, s47
    s_cmp_eq_u32 s36, 0x8000
    s_cselect_b32 s44, 0xffffa000, s47
    s_cselect_b32 s36, 0, s36
    v_add_u32 v112, s44, v112
    v_add_u32 v113, s44, v113
    v_mfma_f32_32x32x16_bf16 v[48:63], a[104:107], v[88:91], v[48:63]
    v_fma_f32 v8, v8, s28, -v120
    v_fma_f32 v9, v9, s28, -v120
    v_exp_f32 v6, v6
    v_exp_f32 v7, v7
    v_add_f32 v125, v125, v4
    v_add_f32 v126, v126, v5
    v_cvt_pk_bf16_f32 v2, v4, v5
    v_mfma_f32_32x32x16_bf16 v[48:63], a[108:111], v[92:95], v[48:63]
    v_fma_f32 v10, v10, s28, -v120
    v_fma_f32 v11, v11, s28, -v120
    v_exp_f32 v8, v8
    v_exp_f32 v9, v9
    v_add_f32 v125, v125, v6
    v_add_f32 v126, v126, v7
    v_cvt_pk_bf16_f32 v3, v6, v7
    v_mfma_f32_32x32x16_bf16 v[48:63], a[112:115], v[96:99], v[48:63]
    ds_write_b128 v114, v[0:3] offset:0
    v_fma_f32 v12, v12, s28, -v120
    v_fma_f32 v13, v13, s28, -v120
    v_exp_f32 v10, v10
    v_exp_f32 v11, v11
    v_add_f32 v125, v125, v8
    v_add_f32 v126, v126, v9
    v_cvt_pk_bf16_f32 v8, v8, v9
    v_mfma_f32_32x32x16_bf16 v[48:63], a[116:119], v[100:103], v[48:63]
    v_fma_f32 v14, v14, s28, -v120
    v_fma_f32 v15, v15, s28, -v120
    v_exp_f32 v12, v12
    v_exp_f32 v13, v13
    v_add_f32 v125, v125, v10
    v_add_f32 v126, v126, v11
    v_cvt_pk_bf16_f32 v9, v10, v11
    v_mfma_f32_32x32x16_bf16 v[48:63], a[120:123], v[104:107], v[48:63]
    v_fma_f32 v16, v16, s28, -v120
    v_fma_f32 v17, v17, s28, -v120
    v_exp_f32 v14, v14
    v_exp_f32 v15, v15
    v_add_f32 v125, v125, v12
    v_add_f32 v126, v126, v13
    v_cvt_pk_bf16_f32 v10, v12, v13
    v_mfma_f32_32x32x16_bf16 v[48:63], a[124:127], v[108:111], v[48:63]
    v_fma_f32 v18, v18, s28, -v120
    v_fma_f32 v19, v19, s28, -v120
    v_exp_f32 v16, v16
    v_exp_f32 v17, v17
    v_add_f32 v125, v125, v14
    v_add_f32 v126, v126, v15
    v_cvt_pk_bf16_f32 v11, v14, v15
    ds_write_b128 v114, v[8:11] offset:1024
    v_fma_f32 v20, v20, s28, -v120
    v_fma_f32 v21, v21, s28, -v120
    v_exp_f32 v18, v18
    v_exp_f32 v19, v19
    v_add_f32 v125, v125, v16
    v_add_f32 v126, v126, v17
    v_cvt_pk_bf16_f32 v16, v16, v17
    v_mfma_f32_32x32x16_bf16 v[0:15], a[0:3], v[80:83], 0
    v_fma_f32 v22, v22, s28, -v120
    v_fma_f32 v23, v23, s28, -v120
    v_exp_f32 v20, v20
    v_exp_f32 v21, v21
    v_add_f32 v125, v125, v18
    v_add_f32 v126, v126, v19
    v_cvt_pk_bf16_f32 v17, v18, v19
    v_max3_f32 v116, v48, v49, v50
    v_mfma_f32_32x32x16_bf16 v[0:15], a[4:7], v[84:87], v[0:15]
    v_fma_f32 v24, v24, s28, -v120
    v_fma_f32 v25, v25, s28, -v120
    v_exp_f32 v22, v22
    v_exp_f32 v23, v23
    v_add_f32 v125, v125, v20
    v_add_f32 v126, v126, v21
    v_cvt_pk_bf16_f32 v18, v20, v21
    v_max3_f32 v117, v51, v52, v53
    v_mfma_f32_32x32x16_bf16 v[0:15], a[8:11], v[88:91], v[0:15]
    v_fma_f32 v26, v26, s28, -v120
    v_fma_f32 v27, v27, s28, -v120
    v_exp_f32 v24, v24
    v_exp_f32 v25, v25
    v_add_f32 v125, v125, v22
    v_add_f32 v126, v126, v23
    v_cvt_pk_bf16_f32 v19, v22, v23
    v_max3_f32 v116, v116, v54, v55
    v_mfma_f32_32x32x16_bf16 v[0:15], a[12:15], v[92:95], v[0:15]
    ds_write_b128 v114, v[16:19] offset:2048
    v_fma_f32 v28, v28, s28, -v120
    v_fma_f32 v29, v29, s28, -v120
    v_exp_f32 v26, v26
    v_exp_f32 v27, v27
    v_add_f32 v125, v125, v24
    v_add_f32 v126, v126, v25
    v_cvt_pk_bf16_f32 v24, v24, v25
    v_max3_f32 v117, v117, v56, v57
    v_mfma_f32_32x32x16_bf16 v[0:15], a[16:19], v[96:99], v[0:15]
    v_fma_f32 v30, v30, s28, -v120
    v_fma_f32 v31, v31, s28, -v120
    v_exp_f32 v28, v28
    v_exp_f32 v29, v29
    v_add_f32 v125, v125, v26
    v_add_f32 v126, v126, v27
    v_cvt_pk_bf16_f32 v25, v26, v27
    v_max3_f32 v116, v116, v58, v59
    v_mfma_f32_32x32x16_bf16 v[0:15], a[20:23], v[100:103], v[0:15]
    v_fma_f32 v32, v32, s28, -v120
    v_fma_f32 v33, v33, s28, -v120
    v_exp_f32 v30, v30
    v_exp_f32 v31, v31
    v_add_f32 v125, v125, v28
    v_add_f32 v126, v126, v29
    v_cvt_pk_bf16_f32 v26, v28, v29
    v_max3_f32 v117, v117, v60, v61
    v_mfma_f32_32x32x16_bf16 v[0:15], a[24:27], v[104:107], v[0:15]
    v_fma_f32 v34, v34, s28, -v120
    v_fma_f32 v35, v35, s28, -v120
    v_exp_f32 v32, v32
    v_exp_f32 v33, v33
    v_add_f32 v125, v125, v30
    v_add_f32 v126, v126, v31
    v_cvt_pk_bf16_f32 v27, v30, v31
    v_max3_f32 v116, v116, v62, v63
    v_mfma_f32_32x32x16_bf16 v[0:15], a[28:31], v[108:111], v[0:15]
    ds_write_b128 v114, v[24:27] offset:3072
    v_fma_f32 v36, v36, s28, -v120
    v_fma_f32 v37, v37, s28, -v120
    v_exp_f32 v34, v34
    v_exp_f32 v35, v35
    v_add_f32 v125, v125, v32
    v_add_f32 v126, v126, v33
    v_cvt_pk_bf16_f32 v32, v32, v33
    v_mfma_f32_32x32x16_bf16 v[16:31], a[32:35], v[80:83], 0
    v_fma_f32 v38, v38, s28, -v120
    v_fma_f32 v39, v39, s28, -v120
    v_exp_f32 v36, v36
    v_exp_f32 v37, v37
    v_add_f32 v125, v125, v34
    v_add_f32 v126, v126, v35
    v_cvt_pk_bf16_f32 v33, v34, v35
    v_mfma_f32_32x32x16_bf16 v[16:31], a[36:39], v[84:87], v[16:31]
    v_fma_f32 v40, v40, s28, -v120
    v_fma_f32 v41, v41, s28, -v120
    v_exp_f32 v38, v38
    v_exp_f32 v39, v39
    v_add_f32 v125, v125, v36
    v_add_f32 v126, v126, v37
    v_cvt_pk_bf16_f32 v34, v36, v37
    v_max3_f32 v116, v116, v0, v1
    v_mfma_f32_32x32x16_bf16 v[16:31], a[40:43], v[88:91], v[16:31]
    v_fma_f32 v42, v42, s28, -v120
    v_fma_f32 v43, v43, s28, -v120
    v_exp_f32 v40, v40
    v_exp_f32 v41, v41
    v_add_f32 v125, v125, v38
    v_add_f32 v126, v126, v39
    v_cvt_pk_bf16_f32 v35, v38, v39
    v_max3_f32 v117, v117, v2, v3
    v_mfma_f32_32x32x16_bf16 v[16:31], a[44:47], v[92:95], v[16:31]
    ds_write_b128 v114, v[32:35] offset:4096
    v_fma_f32 v44, v44, s28, -v120
    v_fma_f32 v45, v45, s28, -v120
    v_exp_f32 v42, v42
    v_exp_f32 v43, v43
    v_add_f32 v125, v125, v40
    v_add_f32 v126, v126, v41
    v_cvt_pk_bf16_f32 v40, v40, v41
    v_max3_f32 v116, v116, v4, v5
    v_mfma_f32_32x32x16_bf16 v[16:31], a[48:51], v[96:99], v[16:31]
    v_fma_f32 v46, v46, s28, -v120
    v_fma_f32 v47, v47, s28, -v120
    v_exp_f32 v44, v44
    v_exp_f32 v45, v45
    v_add_f32 v125, v125, v42
    v_add_f32 v126, v126, v43
    v_cvt_pk_bf16_f32 v41, v42, v43
    v_max3_f32 v117, v117, v6, v7
    v_mfma_f32_32x32x16_bf16 v[16:31], a[52:55], v[100:103], v[16:31]
    v_fma_f32 v64, v64, s28, -v120
    v_fma_f32 v65, v65, s28, -v120
    v_exp_f32 v46, v46
    v_exp_f32 v47, v47
    v_add_f32 v125, v125, v44
    v_add_f32 v126, v126, v45
    v_cvt_pk_bf16_f32 v42, v44, v45
    v_max3_f32 v116, v116, v8, v9
    v_mfma_f32_32x32x16_bf16 v[16:31], a[56:59], v[104:107], v[16:31]
    v_fma_f32 v66, v66, s28, -v120
    v_fma_f32 v67, v67, s28, -v120
    v_exp_f32 v64, v64
    v_exp_f32 v65, v65
    v_add_f32 v125, v125, v46
    v_add_f32 v126, v126, v47
    v_cvt_pk_bf16_f32 v43, v46, v47
    v_max3_f32 v117, v117, v10, v11
    v_mfma_f32_32x32x16_bf16 v[16:31], a[60:63], v[108:111], v[16:31]
    ds_write_b128 v114, v[40:43] offset:5120
    v_fma_f32 v68, v68, s28, -v120
    v_fma_f32 v69, v69, s28, -v120
    v_exp_f32 v66, v66
    v_exp_f32 v67, v67
    v_add_f32 v125, v125, v64
    v_add_f32 v126, v126, v65
    v_cvt_pk_bf16_f32 v64, v64, v65
    v_max3_f32 v116, v116, v12, v13
    v_mfma_f32_32x32x16_bf16 v[32:47], a[64:67], v[80:83], 0
    ds_read_b128 v[80:83], v112 offset:0
    v_fma_f32 v70, v70, s28, -v120
    v_fma_f32 v71, v71, s28, -v120
    v_exp_f32 v68, v68
    v_exp_f32 v69, v69
    v_mfma_f32_32x32x16_bf16 v[32:47], a[68:71], v[84:87], v[32:47]
    ds_read_b128 v[84:87], v113 offset:0
    v_add_f32 v125, v125, v66
    v_add_f32 v126, v126, v67
    v_cvt_pk_bf16_f32 v65, v66, v67
    v_max3_f32 v117, v117, v14, v15
    v_mfma_f32_32x32x16_bf16 v[32:47], a[72:75], v[88:91], v[32:47]
    ds_read_b128 v[88:91], v112 offset:1024
    v_fma_f32 v72, v72, s28, -v120
    v_fma_f32 v73, v73, s28, -v120
    v_exp_f32 v70, v70
    v_exp_f32 v71, v71
    v_mfma_f32_32x32x16_bf16 v[32:47], a[76:79], v[92:95], v[32:47]
    ds_read_b128 v[92:95], v113 offset:1024
    v_add_f32 v125, v125, v68
    v_add_f32 v126, v126, v69
    v_cvt_pk_bf16_f32 v66, v68, v69
    v_max3_f32 v116, v116, v16, v17
    v_max3_f32 v117, v117, v18, v19
    v_mfma_f32_32x32x16_bf16 v[32:47], a[80:83], v[96:99], v[32:47]
    ds_read_b128 v[96:99], v112 offset:2048
    v_fma_f32 v74, v74, s28, -v120
    v_fma_f32 v75, v75, s28, -v120
    v_exp_f32 v72, v72
    v_exp_f32 v73, v73
    v_mfma_f32_32x32x16_bf16 v[32:47], a[84:87], v[100:103], v[32:47]
    ds_read_b128 v[100:103], v113 offset:2048
    v_add_f32 v125, v125, v70
    v_add_f32 v126, v126, v71
    v_cvt_pk_bf16_f32 v67, v70, v71
    v_max3_f32 v116, v116, v20, v21
    v_max3_f32 v117, v117, v22, v23
    v_mfma_f32_32x32x16_bf16 v[32:47], a[88:91], v[104:107], v[32:47]
    ds_read_b128 v[104:107], v112 offset:3072
    ds_write_b128 v114, v[64:67] offset:6144
    v_fma_f32 v76, v76, s28, -v120
    v_fma_f32 v77, v77, s28, -v120
    v_exp_f32 v74, v74
    v_exp_f32 v75, v75
    v_mfma_f32_32x32x16_bf16 v[32:47], a[92:95], v[108:111], v[32:47]
    ds_read_b128 v[108:111], v113 offset:3072
    v_add_f32 v125, v125, v72
    v_add_f32 v126, v126, v73
    v_cvt_pk_bf16_f32 v72, v72, v73
    v_max3_f32 v116, v116, v24, v25
    v_max3_f32 v117, v117, v26, v27
    v_fma_f32 v78, v78, s28, -v120
    v_fma_f32 v79, v79, s28, -v120
    v_exp_f32 v76, v76
    v_exp_f32 v77, v77
    v_add_f32 v125, v125, v74
    v_add_f32 v126, v126, v75
    v_cvt_pk_bf16_f32 v73, v74, v75
    v_max3_f32 v116, v116, v28, v29
    v_max3_f32 v117, v117, v30, v31
    v_exp_f32 v78, v78
    v_exp_f32 v79, v79
    v_add_f32 v125, v125, v76
    v_add_f32 v126, v126, v77
    v_cvt_pk_bf16_f32 v74, v76, v77
    v_max3_f32 v116, v116, v32, v33
    v_max3_f32 v117, v117, v34, v35
    v_max3_f32 v116, v116, v36, v37
    v_max3_f32 v117, v117, v38, v39
    v_max3_f32 v116, v116, v40, v41
    v_max3_f32 v117, v117, v42, v43
    v_max3_f32 v116, v116, v44, v45
    v_max3_f32 v117, v117, v46, v47
    v_max_f32 v116, v116, v117
    ds_write_b32 v115, v116 offset:2048
    v_mov_b32 v123, 145408
    v_mov_b32 v121, 1
    ds_add_u32 v123, v121 offset:8
L_psync2:
    ds_read_b32 v121, v123 offset:8
    s_waitcnt lgkmcnt(0)
    v_readfirstlane_b32 s32, v121
    s_sub_u32 s49, s49, 1
    s_cselect_b32 s32, 256, s32
    s_cmp_lt_u32 s32, 256
    s_cbranch_scc1 L_psync2
    ds_read_b128 v[120:123], v124 offset:2064
    ds_read_b128 v[116:119], v124 offset:2048
    v_add_f32 v125, v125, v78
    v_add_f32 v126, v126, v79
    v_cvt_pk_bf16_f32 v75, v78, v79
    ds_write_b128 v114, v[72:75] offset:7168
    v_add_f32 v125, v125, v126
    ds_write_b32 v115, v125 offset:1024
    s_add_u32 s43, s43, s46
    s_cmp_eq_u32 s43, 0x18000
    s_cselect_b32 s44, 0xffff0000, s46
    s_cselect_b32 s43, 0, s43
    v_add_u32 v114, s44, v114
    s_waitcnt lgkmcnt(3)
    v_max3_f32 v120, v120, v121, v122
    s_waitcnt lgkmcnt(2)
    v_max3_f32 v116, v116, v117, v118
    v_max3_f32 v120, v120, v123, v119
    v_max_f32 v116, v116, v120
    v_mul_f32 v120, s28, v116
    s_mov_b32 s31, 7
L_ploop:
    v_fma_f32 v0, v0, s28, -v120
    v_fma_f32 v1, v1, s28, -v120
    v_fma_f32 v2, v2, s28, -v120
    v_fma_f32 v3, v3, s28, -v120
    v_exp_f32 v0, v0
    v_exp_f32 v1, v1
    v_mfma_f32_32x32x16_bf16 v[64:79], a[96:99], v[80:83], 0
    v_fma_f32 v4, v4, s28, -v120
    v_fma_f32 v5, v5, s28, -v120
    v_exp_f32 v2, v2
    v_exp_f32 v3, v3
    v_mov_b32 v125, v0
    v_mov_b32 v126, v1
    v_cvt_pk_bf16_f32 v0, v0, v1
    v_mfma_f32_32x32x16_bf16 v[64:79], a[100:103], v[84:87], v[64:79]
    v_fma_f32 v6, v6, s28, -v120
    v_fma_f32 v7, v7, s28, -v120
    v_exp_f32 v4, v4
    v_exp_f32 v5, v5
    v_add_f32 v125, v125, v2
    v_add_f32 v126, v126, v3
    v_cvt_pk_bf16_f32 v1, v2, v3
    s_add_u32 s36, s36, s47
    s_cmp_eq_u32 s36, 0x8000
    s_cselect_b32 s44, 0xffffa000, s47
    s_cselect_b32 s36, 0, s36
    v_add_u32 v112, s44, v112
    v_add_u32 v113, s44, v113
    v_mfma_f32_32x32x16_bf16 v[64:79], a[104:107], v[88:91], v[64:79]
    v_fma_f32 v8, v8, s28, -v120
    v_fma_f32 v9, v9, s28, -v120
    v_exp_f32 v6, v6
    v_exp_f32 v7, v7
    v_add_f32 v125, v125, v4
    v_add_f32 v126, v126, v5
    v_cvt_pk_bf16_f32 v2, v4, v5
    v_mfma_f32_32x32x16_bf16 v[64:79], a[108:111], v[92:95], v[64:79]
    v_fma_f32 v10, v10, s28, -v120
    v_fma_f32 v11, v11, s28, -v120
    v_exp_f32 v8, v8
    v_exp_f32 v9, v9
    v_add_f32 v125, v125, v6
    v_add_f32 v126, v126, v7
    v_cvt_pk_bf16_f32 v3, v6, v7
    v_mfma_f32_32x32x16_bf16 v[64:79], a[112:115], v[96:99], v[64:79]
    ds_write_b128 v114, v[0:3] offset:0
    v_fma_f32 v12, v12, s28, -v120
    v_fma_f32 v13, v13, s28, -v120
    v_exp_f32 v10, v10
    v_exp_f32 v11, v11
    v_add_f32 v125, v125, v8
    v_add_f32 v126, v126, v9
    v_cvt_pk_bf16_f32 v8, v8, v9
    v_mfma_f32_32x32x16_bf16 v[64:79], a[116:119], v[100:103], v[64:79]
    v_fma_f32 v14, v14, s28, -v120
    v_fma_f32 v15, v15, s28, -v120
    v_exp_f32 v12, v12
    v_exp_f32 v13, v13
    v_add_f32 v125, v125, v10
    v_add_f32 v126, v126, v11
    v_cvt_pk_bf16_f32 v9, v10, v11
    v_mfma_f32_32x32x16_bf16 v[64:79], a[120:123], v[104:107], v[64:79]
    v_fma_f32 v16, v16, s28, -v120
    v_fma_f32 v17, v17, s28, -v120
    v_exp_f32 v14, v14
    v_exp_f32 v15, v15
    v_add_f32 v125, v125, v12
    v_add_f32 v126, v126, v13
    v_cvt_pk_bf16_f32 v10, v12, v13
    v_mfma_f32_32x32x16_bf16 v[64:79], a[124:127], v[108:111], v[64:79]
    v_fma_f32 v18, v18, s28, -v120
    v_fma_f32 v19, v19, s28, -v120
    v_exp_f32 v16, v16
    v_exp_f32 v17, v17
    v_add_f32 v125, v125, v14
    v_add_f32 v126, v126, v15
    v_cvt_pk_bf16_f32 v11, v14, v15
    ds_write_b128 v114, v[8:11] offset:1024
    v_fma_f32 v20, v20, s28, -v120
    v_fma_f32 v21, v21, s28, -v120
    v_exp_f32 v18, v18
    v_exp_f32 v19, v19
    v_add_f32 v125, v125, v16
    v_add_f32 v126, v126, v17
    v_cvt_pk_bf16_f32 v16, v16, v17
    v_mfma_f32_32x32x16_bf16 v[0:15], a[0:3], v[80:83], 0
    v_fma_f32 v22, v22, s28, -v120
    v_fma_f32 v23, v23, s28, -v120
    v_exp_f32 v20, v20
    v_exp_f32 v21, v21
    v_add_f32 v125, v125, v18
    v_add_f32 v126, v126, v19
    v_cvt_pk_bf16_f32 v17, v18, v19
    v_max3_f32 v116, v64, v65, v66
    v_mfma_f32_32x32x16_bf16 v[0:15], a[4:7], v[84:87], v[0:15]
    v_fma_f32 v24, v24, s28, -v120
    v_fma_f32 v25, v25, s28, -v120
    v_exp_f32 v22, v22
    v_exp_f32 v23, v23
    v_add_f32 v125, v125, v20
    v_add_f32 v126, v126, v21
    v_cvt_pk_bf16_f32 v18, v20, v21
    v_max3_f32 v117, v67, v68, v69
    v_mfma_f32_32x32x16_bf16 v[0:15], a[8:11], v[88:91], v[0:15]
    v_fma_f32 v26, v26, s28, -v120
    v_fma_f32 v27, v27, s28, -v120
    v_exp_f32 v24, v24
    v_exp_f32 v25, v25
    v_add_f32 v125, v125, v22
    v_add_f32 v126, v126, v23
    v_cvt_pk_bf16_f32 v19, v22, v23
    v_max3_f32 v116, v116, v70, v71
    v_mfma_f32_32x32x16_bf16 v[0:15], a[12:15], v[92:95], v[0:15]
    ds_write_b128 v114, v[16:19] offset:2048
    v_fma_f32 v28, v28, s28, -v120
    v_fma_f32 v29, v29, s28, -v120
    v_exp_f32 v26, v26
    v_exp_f32 v27, v27
    v_add_f32 v125, v125, v24
    v_add_f32 v126, v126, v25
    v_cvt_pk_bf16_f32 v24, v24, v25
    v_max3_f32 v117, v117, v72, v73
    v_mfma_f32_32x32x16_bf16 v[0:15], a[16:19], v[96:99], v[0:15]
    v_fma_f32 v30, v30, s28, -v120
    v_fma_f32 v31, v31, s28, -v120
    v_exp_f32 v28, v28
    v_exp_f32 v29, v29
    v_add_f32 v125, v125, v26
    v_add_f32 v126, v126, v27
    v_cvt_pk_bf16_f32 v25, v26, v27
    v_max3_f32 v116, v116, v74, v75
    v_mfma_f32_32x32x16_bf16 v[0:15], a[20:23], v[100:103], v[0:15]
    v_fma_f32 v32, v32, s28, -v120
    v_fma_f32 v33, v33, s28, -v120
    v_exp_f32 v30, v30
    v_exp_f32 v31, v31
    v_add_f32 v125, v125, v28
    v_add_f32 v126, v126, v29
    v_cvt_pk_bf16_f32 v26, v28, v29
    v_max3_f32 v117, v117, v76, v77
    v_mfma_f32_32x32x16_bf16 v[0:15], a[24:27], v[104:107], v[0:15]
    v_fma_f32 v34, v34, s28, -v120
    v_fma_f32 v35, v35, s28, -v120
    v_exp_f32 v32, v32
    v_exp_f32 v33, v33
    v_add_f32 v125, v125, v30
    v_add_f32 v126, v126, v31
    v_cvt_pk_bf16_f32 v27, v30, v31
    v_max3_f32 v116, v116, v78, v79
    v_mfma_f32_32x32x16_bf16 v[0:15], a[28:31], v[108:111], v[0:15]
    ds_write_b128 v114, v[24:27] offset:3072
    v_fma_f32 v36, v36, s28, -v120
    v_fma_f32 v37, v37, s28, -v120
    v_exp_f32 v34, v34
    v_exp_f32 v35, v35
    v_add_f32 v125, v125, v32
    v_add_f32 v126, v126, v33
    v_cvt_pk_bf16_f32 v32, v32, v33
    v_mfma_f32_32x32x16_bf16 v[16:31], a[32:35], v[80:83], 0
    v_fma_f32 v38, v38, s28, -v120
    v_fma_f32 v39, v39, s28, -v120
    v_exp_f32 v36, v36
    v_exp_f32 v37, v37
    v_add_f32 v125, v125, v34
    v_add_f32 v126, v126, v35
    v_cvt_pk_bf16_f32 v33, v34, v35
    v_mfma_f32_32x32x16_bf16 v[16:31], a[36:39], v[84:87], v[16:31]
    v_fma_f32 v40, v40, s28, -v120
    v_fma_f32 v41, v41, s28, -v120
    v_exp_f32 v38, v38
    v_exp_f32 v39, v39
    v_add_f32 v125, v125, v36
    v_add_f32 v126, v126, v37
    v_cvt_pk_bf16_f32 v34, v36, v37
    v_max3_f32 v116, v116, v0, v1
    v_mfma_f32_32x32x16_bf16 v[16:31], a[40:43], v[88:91], v[16:31]
    v_fma_f32 v42, v42, s28, -v120
    v_fma_f32 v43, v43, s28, -v120
    v_exp_f32 v40, v40
    v_exp_f32 v41, v41
    v_add_f32 v125, v125, v38
    v_add_f32 v126, v126, v39
    v_cvt_pk_bf16_f32 v35, v38, v39
    v_max3_f32 v117, v117, v2, v3
    v_mfma_f32_32x32x16_bf16 v[16:31], a[44:47], v[92:95], v[16:31]
    ds_write_b128 v114, v[32:35] offset:4096
    v_fma_f32 v44, v44, s28, -v120
    v_fma_f32 v45, v45, s28, -v120
    v_exp_f32 v42, v42
    v_exp_f32 v43, v43
    v_add_f32 v125, v125, v40
    v_add_f32 v126, v126, v41
    v_cvt_pk_bf16_f32 v40, v40, v41
    v_max3_f32 v116, v116, v4, v5
    v_mfma_f32_32x32x16_bf16 v[16:31], a[48:51], v[96:99], v[16:31]
    v_fma_f32 v46, v46, s28, -v120
    v_fma_f32 v47, v47, s28, -v120
    v_exp_f32 v44, v44
    v_exp_f32 v45, v45
    v_add_f32 v125, v125, v42
    v_add_f32 v126, v126, v43
    v_cvt_pk_bf16_f32 v41, v42, v43
    v_max3_f32 v117, v117, v6, v7
    v_mfma_f32_32x32x16_bf16 v[16:31], a[52:55], v[100:103], v[16:31]
    v_fma_f32 v48, v48, s28, -v120
    v_fma_f32 v49, v49, s28, -v120
    v_exp_f32 v46, v46
    v_exp_f32 v47, v47
    v_add_f32 v125, v125, v44
    v_add_f32 v126, v126, v45
    v_cvt_pk_bf16_f32 v42, v44, v45
    v_max3_f32 v116, v116, v8, v9
    v_mfma_f32_32x32x16_bf16 v[16:31], a[56:59], v[104:107], v[16:31]
    v_fma_f32 v50, v50, s28, -v120
    v_fma_f32 v51, v51, s28, -v120
    v_exp_f32 v48, v48
    v_exp_f32 v49, v49
    v_add_f32 v125, v125, v46
    v_add_f32 v126, v126, v47
    v_cvt_pk_bf16_f32 v43, v46, v47
    v_max3_f32 v117, v117, v10, v11
    v_mfma_f32_32x32x16_bf16 v[16:31], a[60:63], v[108:111], v[16:31]
    ds_write_b128 v114, v[40:43] offset:5120
    v_fma_f32 v52, v52, s28, -v120
    v_fma_f32 v53, v53, s28, -v120
    v_exp_f32 v50, v50
    v_exp_f32 v51, v51
    v_add_f32 v125, v125, v48
    v_add_f32 v126, v126, v49
    v_cvt_pk_bf16_f32 v48, v48, v49
    v_max3_f32 v116, v116, v12, v13
    v_mfma_f32_32x32x16_bf16 v[32:47], a[64:67], v[80:83], 0
    ds_read_b128 v[80:83], v112 offset:0
    v_fma_f32 v54, v54, s28, -v120
    v_fma_f32 v55, v55, s28, -v120
    v_exp_f32 v52, v52
    v_exp_f32 v53, v53
    v_mfma_f32_32x32x16_bf16 v[32:47], a[68:71], v[84:87], v[32:47]
    ds_read_b128 v[84:87], v113 offset:0
    v_add_f32 v125, v125, v50
    v_add_f32 v126, v126, v51
    v_cvt_pk_bf16_f32 v49, v50, v51
    v_max3_f32 v117, v117, v14, v15
    v_mfma_f32_32x32x16_bf16 v[32:47], a[72:75], v[88:91], v[32:47]
    ds_read_b128 v[88:91], v112 offset:1024
    v_fma_f32 v56, v56, s28, -v120
    v_fma_f32 v57, v57, s28, -v120
    v_exp_f32 v54, v54
    v_exp_f32 v55, v55
    v_mfma_f32_32x32x16_bf16 v[32:47], a[76:79], v[92:95], v[32:47]
    ds_read_b128 v[92:95], v113 offset:1024
    v_add_f32 v125, v125, v52
    v_add_f32 v126, v126, v53
    v_cvt_pk_bf16_f32 v50, v52, v53
    v_max3_f32 v116, v116, v16, v17
    v_max3_f32 v117, v117, v18, v19
    v_mfma_f32_32x32x16_bf16 v[32:47], a[80:83], v[96:99], v[32:47]
    ds_read_b128 v[96:99], v112 offset:2048
    v_fma_f32 v58, v58, s28, -v120
    v_fma_f32 v59, v59, s28, -v120
    v_exp_f32 v56, v56
    v_exp_f32 v57, v57
    v_mfma_f32_32x32x16_bf16 v[32:47], a[84:87], v[100:103], v[32:47]
    ds_read_b128 v[100:103], v113 offset:2048
    v_add_f32 v125, v125, v54
    v_add_f32 v126, v126, v55
    v_cvt_pk_bf16_f32 v51, v54, v55
    v_max3_f32 v116, v116, v20, v21
    v_max3_f32 v117, v117, v22, v23
    v_mfma_f32_32x32x16_bf16 v[32:47], a[88:91], v[104:107], v[32:47]
    ds_read_b128 v[104:107], v112 offset:3072
    ds_write_b128 v114, v[48:51] offset:6144
    v_fma_f32 v60, v60, s28, -v120
    v_fma_f32 v61, v61, s28, -v120
    v_exp_f32 v58, v58
    v_exp_f32 v59, v59
    v_mfma_f32_32x32x16_bf16 v[32:47], a[92:95], v[108:111], v[32:47]
    ds_read_b128 v[108:111], v113 offset:3072
    v_add_f32 v125, v125, v56
    v_add_f32 v126, v126, v57
    v_cvt_pk_bf16_f32 v56, v56, v57
    v_max3_f32 v116, v116, v24, v25
    v_max3_f32 v117, v117, v26, v27
    v_fma_f32 v62, v62, s28, -v120
    v_fma_f32 v63, v63, s28, -v120
    v_exp_f32 v60, v60
    v_exp_f32 v61, v61
    v_add_f32 v125, v125, v58
    v_add_f32 v126, v126, v59
    v_cvt_pk_bf16_f32 v57, v58, v59
    v_max3_f32 v116, v116, v28, v29
    v_max3_f32 v117, v117, v30, v31
    v_exp_f32 v62, v62
    v_exp_f32 v63, v63
    v_add_f32 v125, v125, v60
    v_add_f32 v126, v126, v61
    v_cvt_pk_bf16_f32 v58, v60, v61
    v_max3_f32 v116, v116, v32, v33
    v_max3_f32 v117, v117, v34, v35
    v_max3_f32 v116, v116, v36, v37
    v_max3_f32 v117, v117, v38, v39
    v_max3_f32 v116, v116, v40, v41
    v_max3_f32 v117, v117, v42, v43
    v_max3_f32 v116, v116, v44, v45
    v_max3_f32 v117, v117, v46, v47
    v_max_f32 v116, v116, v117
    ds_write_b32 v115, v116 offset:3072
    s_waitcnt lgkmcnt(0)
    s_barrier
    ds_read_b128 v[120:123], v124 offset:3088
    ds_read_b128 v[116:119], v124 offset:3072
    v_add_f32 v125, v125, v62
    v_add_f32 v126, v126, v63
    v_cvt_pk_bf16_f32 v59, v62, v63
    ds_write_b128 v114, v[56:59] offset:7168
    v_add_f32 v125, v125, v126
    ds_write_b32 v115, v125 offset:0
    s_add_u32 s43, s43, s46
    s_cmp_eq_u32 s43, 0x18000
    s_cselect_b32 s44, 0xffff0000, s46
    s_cselect_b32 s43, 0, s43
    v_add_u32 v114, s44, v114
    s_waitcnt lgkmcnt(3)
    v_max3_f32 v120, v120, v121, v122
    s_waitcnt lgkmcnt(2)
    v_max3_f32 v116, v116, v117, v118
    v_max3_f32 v120, v120, v123, v119
    v_max_f32 v116, v116, v120
    v_mul_f32 v120, s28, v116
    v_fma_f32 v0, v0, s28, -v120
    v_fma_f32 v1, v1, s28, -v120
    v_fma_f32 v2, v2, s28, -v120
    v_fma_f32 v3, v3, s28, -v120
    v_exp_f32 v0, v0
    v_exp_f32 v1, v1
    v_mfma_f32_32x32x16_bf16 v[48:63], a[96:99], v[80:83], 0
    v_fma_f32 v4, v4, s28, -v120
    v_fma_f32 v5, v5, s28, -v120
    v_exp_f32 v2, v2
    v_exp_f32 v3, v3
    v_mov_b32 v125, v0
    v_mov_b32 v126, v1
    v_cvt_pk_bf16_f32 v0, v0, v1
    v_mfma_f32_32x32x16_bf16 v[48:63], a[100:103], v[84:87], v[48:63]
    v_fma_f32 v6, v6, s28, -v120
    v_fma_f32 v7, v7, s28, -v120
    v_exp_f32 v4, v4
    v_exp_f32 v5, v5
    v_add_f32 v125, v125, v2
    v_add_f32 v126, v126, v3
    v_cvt_pk_bf16_f32 v1, v2, v3
    s_add_u32 s36, s36, s47
    s_cmp_eq_u32 s36, 0x8000
    s_cselect_b32 s44, 0xffffa000, s47
    s_cselect_b32 s36, 0, s36
    v_add_u32 v112, s44, v112
    v_add_u32 v113, s44, v113
    v_mfma_f32_32x32x16_bf16 v[48:63], a[104:107], v[88:91], v[48:63]
    v_fma_f32 v8, v8, s28, -v120
    v_fma_f32 v9, v9, s28, -v120
    v_exp_f32 v6, v6
    v_exp_f32 v7, v7
    v_add_f32 v125, v125, v4
    v_add_f32 v126, v126, v5
    v_cvt_pk_bf16_f32 v2, v4, v5
    v_mfma_f32_32x32x16_bf16 v[48:63], a[108:111], v[92:95], v[48:63]
    v_fma_f32 v10, v10, s28, -v120
    v_fma_f32 v11, v11, s28, -v120
    v_exp_f32 v8, v8
    v_exp_f32 v9, v9
    v_add_f32 v125, v125, v6
    v_add_f32 v126, v126, v7
    v_cvt_pk_bf16_f32 v3, v6, v7
    v_mfma_f32_32x32x16_bf16 v[48:63], a[112:115], v[96:99], v[48:63]
    ds_write_b128 v114, v[0:3] offset:0
    v_fma_f32 v12, v12, s28, -v120
    v_fma_f32 v13, v13, s28, -v120
    v_exp_f32 v10, v10
    v_exp_f32 v11, v11
    v_add_f32 v125, v125, v8
    v_add_f32 v126, v126, v9
    v_cvt_pk_bf16_f32 v8, v8, v9
    v_mfma_f32_32x32x16_bf16 v[48:63], a[116:119], v[100:103], v[48:63]
    v_fma_f32 v14, v14, s28, -v120
    v_fma_f32 v15, v15, s28, -v120
    v_exp_f32 v12, v12
    v_exp_f32 v13, v13
    v_add_f32 v125, v125, v10
    v_add_f32 v126, v126, v11
    v_cvt_pk_bf16_f32 v9, v10, v11
    v_mfma_f32_32x32x16_bf16 v[48:63], a[120:123], v[104:107], v[48:63]
    v_fma_f32 v16, v16, s28, -v120
    v_fma_f32 v17, v17, s28, -v120
    v_exp_f32 v14, v14
    v_exp_f32 v15, v15
    v_add_f32 v125, v125, v12
    v_add_f32 v126, v126, v13
    v_cvt_pk_bf16_f32 v10, v12, v13
    v_mfma_f32_32x32x16_bf16 v[48:63], a[124:127], v[108:111], v[48:63]
    v_fma_f32 v18, v18, s28, -v120
    v_fma_f32 v19, v19, s28, -v120
    v_exp_f32 v16, v16
    v_exp_f32 v17, v17
    v_add_f32 v125, v125, v14
    v_add_f32 v126, v126, v15
    v_cvt_pk_bf16_f32 v11, v14, v15
    ds_write_b128 v114, v[8:11] offset:1024
    v_fma_f32 v20, v20, s28, -v120
    v_fma_f32 v21, v21, s28, -v120
    v_exp_f32 v18, v18
    v_exp_f32 v19, v19
    v_add_f32 v125, v125, v16
    v_add_f32 v126, v126, v17
    v_cvt_pk_bf16_f32 v16, v16, v17
    v_mfma_f32_32x32x16_bf16 v[0:15], a[0:3], v[80:83], 0
    v_fma_f32 v22, v22, s28, -v120
    v_fma_f32 v23, v23, s28, -v120
    v_exp_f32 v20, v20
    v_exp_f32 v21, v21
    v_add_f32 v125, v125, v18
    v_add_f32 v126, v126, v19
    v_cvt_pk_bf16_f32 v17, v18, v19
    v_max3_f32 v116, v48, v49, v50
    v_mfma_f32_32x32x16_bf16 v[0:15], a[4:7], v[84:87], v[0:15]
    v_fma_f32 v24, v24, s28, -v120
    v_fma_f32 v25, v25, s28, -v120
    v_exp_f32 v22, v22
    v_exp_f32 v23, v23
    v_add_f32 v125, v125, v20
    v_add_f32 v126, v126, v21
    v_cvt_pk_bf16_f32 v18, v20, v21
    v_max3_f32 v117, v51, v52, v53
    v_mfma_f32_32x32x16_bf16 v[0:15], a[8:11], v[88:91], v[0:15]
    v_fma_f32 v26, v26, s28, -v120
    v_fma_f32 v27, v27, s28, -v120
    v_exp_f32 v24, v24
    v_exp_f32 v25, v25
    v_add_f32 v125, v125, v22
    v_add_f32 v126, v126, v23
    v_cvt_pk_bf16_f32 v19, v22, v23
    v_max3_f32 v116, v116, v54, v55
    v_mfma_f32_32x32x16_bf16 v[0:15], a[12:15], v[92:95], v[0:15]
    ds_write_b128 v114, v[16:19] offset:2048
    v_fma_f32 v28, v28, s28, -v120
    v_fma_f32 v29, v29, s28, -v120
    v_exp_f32 v26, v26
    v_exp_f32 v27, v27
    v_add_f32 v125, v125, v24
    v_add_f32 v126, v126, v25
    v_cvt_pk_bf16_f32 v24, v24, v25
    v_max3_f32 v117, v117, v56, v57
    v_mfma_f32_32x32x16_bf16 v[0:15], a[16:19], v[96:99], v[0:15]
    v_fma_f32 v30, v30, s28, -v120
    v_fma_f32 v31, v31, s28, -v120
    v_exp_f32 v28, v28
    v_exp_f32 v29, v29
    v_add_f32 v125, v125, v26
    v_add_f32 v126, v126, v27
    v_cvt_pk_bf16_f32 v25, v26, v27
    v_max3_f32 v116, v116, v58, v59
    v_mfma_f32_32x32x16_bf16 v[0:15], a[20:23], v[100:103], v[0:15]
    v_fma_f32 v32, v32, s28, -v120
    v_fma_f32 v33, v33, s28, -v120
    v_exp_f32 v30, v30
    v_exp_f32 v31, v31
    v_add_f32 v125, v125, v28
    v_add_f32 v126, v126, v29
    v_cvt_pk_bf16_f32 v26, v28, v29
    v_max3_f32 v117, v117, v60, v61
    v_mfma_f32_32x32x16_bf16 v[0:15], a[24:27], v[104:107], v[0:15]
    v_fma_f32 v34, v34, s28, -v120
    v_fma_f32 v35, v35, s28, -v120
    v_exp_f32 v32, v32
    v_exp_f32 v33, v33
    v_add_f32 v125, v125, v30
    v_add_f32 v126, v126, v31
    v_cvt_pk_bf16_f32 v27, v30, v31
    v_max3_f32 v116, v116, v62, v63
    v_mfma_f32_32x32x16_bf16 v[0:15], a[28:31], v[108:111], v[0:15]
    ds_write_b128 v114, v[24:27] offset:3072
    v_fma_f32 v36, v36, s28, -v120
    v_fma_f32 v37, v37, s28, -v120
    v_exp_f32 v34, v34
    v_exp_f32 v35, v35
    v_add_f32 v125, v125, v32
    v_add_f32 v126, v126, v33
    v_cvt_pk_bf16_f32 v32, v32, v33
    v_mfma_f32_32x32x16_bf16 v[16:31], a[32:35], v[80:83], 0
    v_fma_f32 v38, v38, s28, -v120
    v_fma_f32 v39, v39, s28, -v120
    v_exp_f32 v36, v36
    v_exp_f32 v37, v37
    v_add_f32 v125, v125, v34
    v_add_f32 v126, v126, v35
    v_cvt_pk_bf16_f32 v33, v34, v35
    v_mfma_f32_32x32x16_bf16 v[16:31], a[36:39], v[84:87], v[16:31]
    v_fma_f32 v40, v40, s28, -v120
    v_fma_f32 v41, v41, s28, -v120
    v_exp_f32 v38, v38
    v_exp_f32 v39, v39
    v_add_f32 v125, v125, v36
    v_add_f32 v126, v126, v37
    v_cvt_pk_bf16_f32 v34, v36, v37
    v_max3_f32 v116, v116, v0, v1
    v_mfma_f32_32x32x16_bf16 v[16:31], a[40:43], v[88:91], v[16:31]
    v_fma_f32 v42, v42, s28, -v120
    v_fma_f32 v43, v43, s28, -v120
    v_exp_f32 v40, v40
    v_exp_f32 v41, v41
    v_add_f32 v125, v125, v38
    v_add_f32 v126, v126, v39
    v_cvt_pk_bf16_f32 v35, v38, v39
    v_max3_f32 v117, v117, v2, v3
    v_mfma_f32_32x32x16_bf16 v[16:31], a[44:47], v[92:95], v[16:31]
    ds_write_b128 v114, v[32:35] offset:4096
    v_fma_f32 v44, v44, s28, -v120
    v_fma_f32 v45, v45, s28, -v120
    v_exp_f32 v42, v42
    v_exp_f32 v43, v43
    v_add_f32 v125, v125, v40
    v_add_f32 v126, v126, v41
    v_cvt_pk_bf16_f32 v40, v40, v41
    v_max3_f32 v116, v116, v4, v5
    v_mfma_f32_32x32x16_bf16 v[16:31], a[48:51], v[96:99], v[16:31]
    v_fma_f32 v46, v46, s28, -v120
    v_fma_f32 v47, v47, s28, -v120
    v_exp_f32 v44, v44
    v_exp_f32 v45, v45
    v_add_f32 v125, v125, v42
    v_add_f32 v126, v126, v43
    v_cvt_pk_bf16_f32 v41, v42, v43
    v_max3_f32 v117, v117, v6, v7
    v_mfma_f32_32x32x16_bf16 v[16:31], a[52:55], v[100:103], v[16:31]
    v_fma_f32 v64, v64, s28, -v120
    v_fma_f32 v65, v65, s28, -v120
    v_exp_f32 v46, v46
    v_exp_f32 v47, v47
    v_add_f32 v125, v125, v44
    v_add_f32 v126, v126, v45
    v_cvt_pk_bf16_f32 v42, v44, v45
    v_max3_f32 v116, v116, v8, v9
    v_mfma_f32_32x32x16_bf16 v[16:31], a[56:59], v[104:107], v[16:31]
    v_fma_f32 v66, v66, s28, -v120
    v_fma_f32 v67, v67, s28, -v120
    v_exp_f32 v64, v64
    v_exp_f32 v65, v65
    v_add_f32 v125, v125, v46
    v_add_f32 v126, v126, v47
    v_cvt_pk_bf16_f32 v43, v46, v47
    v_max3_f32 v117, v117, v10, v11
    v_mfma_f32_32x32x16_bf16 v[16:31], a[60:63], v[108:111], v[16:31]
    ds_write_b128 v114, v[40:43] offset:5120
    v_fma_f32 v68, v68, s28, -v120
    v_fma_f32 v69, v69, s28, -v120
    v_exp_f32 v66, v66
    v_exp_f32 v67, v67
    v_add_f32 v125, v125, v64
    v_add_f32 v126, v126, v65
    v_cvt_pk_bf16_f32 v64, v64, v65
    v_max3_f32 v116, v116, v12, v13
    v_mfma_f32_32x32x16_bf16 v[32:47], a[64:67], v[80:83], 0
    ds_read_b128 v[80:83], v112 offset:0
    v_fma_f32 v70, v70, s28, -v120
    v_fma_f32 v71, v71, s28, -v120
    v_exp_f32 v68, v68
    v_exp_f32 v69, v69
    v_mfma_f32_32x32x16_bf16 v[32:47], a[68:71], v[84:87], v[32:47]
    ds_read_b128 v[84:87], v113 offset:0
    v_add_f32 v125, v125, v66
    v_add_f32 v126, v126, v67
    v_cvt_pk_bf16_f32 v65, v66, v67
    v_max3_f32 v117, v117, v14, v15
    v_mfma_f32_32x32x16_bf16 v[32:47], a[72:75], v[88:91], v[32:47]
    ds_read_b128 v[88:91], v112 offset:1024
    v_fma_f32 v72, v72, s28, -v120
    v_fma_f32 v73, v73, s28, -v120
    v_exp_f32 v70, v70
    v_exp_f32 v71, v71
    v_mfma_f32_32x32x16_bf16 v[32:47], a[76:79], v[92:95], v[32:47]
    ds_read_b128 v[92:95], v113 offset:1024
    v_add_f32 v125, v125, v68
    v_add_f32 v126, v126, v69
    v_cvt_pk_bf16_f32 v66, v68, v69
    v_max3_f32 v116, v116, v16, v17
    v_max3_f32 v117, v117, v18, v19
    v_mfma_f32_32x32x16_bf16 v[32:47], a[80:83], v[96:99], v[32:47]
    ds_read_b128 v[96:99], v112 offset:2048
    v_fma_f32 v74, v74, s28, -v120
    v_fma_f32 v75, v75, s28, -v120
    v_exp_f32 v72, v72
    v_exp_f32 v73, v73
    v_mfma_f32_32x32x16_bf16 v[32:47], a[84:87], v[100:103], v[32:47]
    ds_read_b128 v[100:103], v113 offset:2048
    v_add_f32 v125, v125, v70
    v_add_f32 v126, v126, v71
    v_cvt_pk_bf16_f32 v67, v70, v71
    v_max3_f32 v116, v116, v20, v21
    v_max3_f32 v117, v117, v22, v23
    v_mfma_f32_32x32x16_bf16 v[32:47], a[88:91], v[104:107], v[32:47]
    ds_read_b128 v[104:107], v112 offset:3072
    ds_write_b128 v114, v[64:67] offset:6144
    v_fma_f32 v76, v76, s28, -v120
    v_fma_f32 v77, v77, s28, -v120
    v_exp_f32 v74, v74
    v_exp_f32 v75, v75
    v_mfma_f32_32x32x16_bf16 v[32:47], a[92:95], v[108:111], v[32:47]
    ds_read_b128 v[108:111], v113 offset:3072
    v_add_f32 v125, v125, v72
    v_add_f32 v126, v126, v73
    v_cvt_pk_bf16_f32 v72, v72, v73
    v_max3_f32 v116, v116, v24, v25
    v_max3_f32 v117, v117, v26, v27
    v_fma_f32 v78, v78, s28, -v120
    v_fma_f32 v79, v79, s28, -v120
    v_exp_f32 v76, v76
    v_exp_f32 v77, v77
    v_add_f32 v125, v125, v74
    v_add_f32 v126, v126, v75
    v_cvt_pk_bf16_f32 v73, v74, v75
    v_max3_f32 v116, v116, v28, v29
    v_max3_f32 v117, v117, v30, v31
    v_exp_f32 v78, v78
    v_exp_f32 v79, v79
    v_add_f32 v125, v125, v76
    v_add_f32 v126, v126, v77
    v_cvt_pk_bf16_f32 v74, v76, v77
    v_max3_f32 v116, v116, v32, v33
    v_max3_f32 v117, v117, v34, v35
    v_max3_f32 v116, v116, v36, v37
    v_max3_f32 v117, v117, v38, v39
    v_max3_f32 v116, v116, v40, v41
    v_max3_f32 v117, v117, v42, v43
    v_max3_f32 v116, v116, v44, v45
    v_max3_f32 v117, v117, v46, v47
    v_max_f32 v116, v116, v117
    ds_write_b32 v115, v116 offset:2048
    s_waitcnt lgkmcnt(0)
    s_barrier
    ds_read_b128 v[120:123], v124 offset:2064
    ds_read_b128 v[116:119], v124 offset:2048
    v_add_f32 v125, v125, v78
    v_add_f32 v126, v126, v79
    v_cvt_pk_bf16_f32 v75, v78, v79
    ds_write_b128 v114, v[72:75] offset:7168
    v_add_f32 v125, v125, v126
    ds_write_b32 v115, v125 offset:1024
    s_add_u32 s43, s43, s46
    s_cmp_eq_u32 s43, 0x18000
    s_cselect_b32 s44, 0xffff0000, s46
    s_cselect_b32 s43, 0, s43
    v_add_u32 v114, s44, v114
    s_waitcnt lgkmcnt(3)
    v_max3_f32 v120, v120, v121, v122
    s_waitcnt lgkmcnt(2)
    v_max3_f32 v116, v116, v117, v118
    v_max3_f32 v120, v120, v123, v119
    v_max_f32 v116, v116, v120
    v_mul_f32 v120, s28, v116
    s_sub_u32 s31, s31, 1
    s_cmp_lg_u32 s31, 0
    s_cbranch_scc1 L_ploop
    v_fma_f32 v0, v0, s28, -v120
    v_fma_f32 v1, v1, s28, -v120
    v_fma_f32 v2, v2, s28, -v120
    v_fma_f32 v3, v3, s28, -v120
    v_exp_f32 v0, v0
    v_exp_f32 v1, v1
    v_mfma_f32_32x32x16_bf16 v[64:79], a[96:99], v[80:83], 0
    v_fma_f32 v4, v4, s28, -v120
    v_fma_f32 v5, v5, s28, -v120
    v_exp_f32 v2, v2
    v_exp_f32 v3, v3
    v_mov_b32 v125, v0
    v_mov_b32 v126, v1
    v_cvt_pk_bf16_f32 v0, v0, v1
    v_mfma_f32_32x32x16_bf16 v[64:79], a[100:103], v[84:87], v[64:79]
    v_fma_f32 v6, v6, s28, -v120
    v_fma_f32 v7, v7, s28, -v120
    v_exp_f32 v4, v4
    v_exp_f32 v5, v5
    v_add_f32 v125, v125, v2
    v_add_f32 v126, v126, v3
    v_cvt_pk_bf16_f32 v1, v2, v3
    s_add_u32 s36, s36, s47
    s_cmp_eq_u32 s36, 0x8000
    s_cselect_b32 s44, 0xffffa000, s47
    s_cselect_b32 s36, 0, s36
    v_add_u32 v112, s44, v112
    v_add_u32 v113, s44, v113
    v_mfma_f32_32x32x16_bf16 v[64:79], a[104:107], v[88:91], v[64:79]
    v_fma_f32 v8, v8, s28, -v120
    v_fma_f32 v9, v9, s28, -v120
    v_exp_f32 v6, v6
    v_exp_f32 v7, v7
    v_add_f32 v125, v125, v4
    v_add_f32 v126, v126, v5
    v_cvt_pk_bf16_f32 v2, v4, v5
    v_mfma_f32_32x32x16_bf16 v[64:79], a[108:111], v[92:95], v[64:79]
    v_fma_f32 v10, v10, s28, -v120
    v_fma_f32 v11, v11, s28, -v120
    v_exp_f32 v8, v8
    v_exp_f32 v9, v9
    v_add_f32 v125, v125, v6
    v_add_f32 v126, v126, v7
    v_cvt_pk_bf16_f32 v3, v6, v7
    v_mfma_f32_32x32x16_bf16 v[64:79], a[112:115], v[96:99], v[64:79]
    ds_write_b128 v114, v[0:3] offset:0
    v_fma_f32 v12, v12, s28, -v120
    v_fma_f32 v13, v13, s28, -v120
    v_exp_f32 v10, v10
    v_exp_f32 v11, v11
    v_add_f32 v125, v125, v8
    v_add_f32 v126, v126, v9
    v_cvt_pk_bf16_f32 v8, v8, v9
    v_mfma_f32_32x32x16_bf16 v[64:79], a[116:119], v[100:103], v[64:79]
    v_fma_f32 v14, v14, s28, -v120
    v_fma_f32 v15, v15, s28, -v120
    v_exp_f32 v12, v12
    v_exp_f32 v13, v13
    v_add_f32 v125, v125, v10
    v_add_f32 v126, v126, v11
    v_cvt_pk_bf16_f32 v9, v10, v11
    v_mfma_f32_32x32x16_bf16 v[64:79], a[120:123], v[104:107], v[64:79]
    v_fma_f32 v16, v16, s28, -v120
    v_fma_f32 v17, v17, s28, -v120
    v_exp_f32 v14, v14
    v_exp_f32 v15, v15
    v_add_f32 v125, v125, v12
    v_add_f32 v126, v126, v13
    v_cvt_pk_bf16_f32 v10, v12, v13
    v_mfma_f32_32x32x16_bf16 v[64:79], a[124:127], v[108:111], v[64:79]
    v_fma_f32 v18, v18, s28, -v120
    v_fma_f32 v19, v19, s28, -v120
    v_exp_f32 v16, v16
    v_exp_f32 v17, v17
    v_add_f32 v125, v125, v14
    v_add_f32 v126, v126, v15
    v_cvt_pk_bf16_f32 v11, v14, v15
    ds_write_b128 v114, v[8:11] offset:1024
    v_fma_f32 v20, v20, s28, -v120
    v_fma_f32 v21, v21, s28, -v120
    v_exp_f32 v18, v18
    v_exp_f32 v19, v19
    v_add_f32 v125, v125, v16
    v_add_f32 v126, v126, v17
    v_cvt_pk_bf16_f32 v16, v16, v17
    v_mfma_f32_32x32x16_bf16 v[0:15], a[0:3], v[80:83], 0
    v_fma_f32 v22, v22, s28, -v120
    v_fma_f32 v23, v23, s28, -v120
    v_exp_f32 v20, v20
    v_exp_f32 v21, v21
    v_add_f32 v125, v125, v18
    v_add_f32 v126, v126, v19
    v_cvt_pk_bf16_f32 v17, v18, v19
    v_max3_f32 v116, v64, v65, v66
    v_mfma_f32_32x32x16_bf16 v[0:15], a[4:7], v[84:87], v[0:15]
    v_fma_f32 v24, v24, s28, -v120
    v_fma_f32 v25, v25, s28, -v120
    v_exp_f32 v22, v22
    v_exp_f32 v23, v23
    v_add_f32 v125, v125, v20
    v_add_f32 v126, v126, v21
    v_cvt_pk_bf16_f32 v18, v20, v21
    v_max3_f32 v117, v67, v68, v69
    v_mfma_f32_32x32x16_bf16 v[0:15], a[8:11], v[88:91], v[0:15]
    v_fma_f32 v26, v26, s28, -v120
    v_fma_f32 v27, v27, s28, -v120
    v_exp_f32 v24, v24
    v_exp_f32 v25, v25
    v_add_f32 v125, v125, v22
    v_add_f32 v126, v126, v23
    v_cvt_pk_bf16_f32 v19, v22, v23
    v_max3_f32 v116, v116, v70, v71
    v_mfma_f32_32x32x16_bf16 v[0:15], a[12:15], v[92:95], v[0:15]
    ds_write_b128 v114, v[16:19] offset:2048
    v_fma_f32 v28, v28, s28, -v120
    v_fma_f32 v29, v29, s28, -v120
    v_exp_f32 v26, v26
    v_exp_f32 v27, v27
    v_add_f32 v125, v125, v24
    v_add_f32 v126, v126, v25
    v_cvt_pk_bf16_f32 v24, v24, v25
    v_max3_f32 v117, v117, v72, v73
    v_mfma_f32_32x32x16_bf16 v[0:15], a[16:19], v[96:99], v[0:15]
    v_fma_f32 v30, v30, s28, -v120
    v_fma_f32 v31, v31, s28, -v120
    v_exp_f32 v28, v28
    v_exp_f32 v29, v29
    v_add_f32 v125, v125, v26
    v_add_f32 v126, v126, v27
    v_cvt_pk_bf16_f32 v25, v26, v27
    v_max3_f32 v116, v116, v74, v75
    v_mfma_f32_32x32x16_bf16 v[0:15], a[20:23], v[100:103], v[0:15]
    v_fma_f32 v32, v32, s28, -v120
    v_fma_f32 v33, v33, s28, -v120
    v_exp_f32 v30, v30
    v_exp_f32 v31, v31
    v_add_f32 v125, v125, v28
    v_add_f32 v126, v126, v29
    v_cvt_pk_bf16_f32 v26, v28, v29
    v_max3_f32 v117, v117, v76, v77
    v_mfma_f32_32x32x16_bf16 v[0:15], a[24:27], v[104:107], v[0:15]
    v_fma_f32 v34, v34, s28, -v120
    v_fma_f32 v35, v35, s28, -v120
    v_exp_f32 v32, v32
    v_exp_f32 v33, v33
    v_add_f32 v125, v125, v30
    v_add_f32 v126, v126, v31
    v_cvt_pk_bf16_f32 v27, v30, v31
    v_max3_f32 v116, v116, v78, v79
    v_mfma_f32_32x32x16_bf16 v[0:15], a[28:31], v[108:111], v[0:15]
    ds_write_b128 v114, v[24:27] offset:3072
    v_fma_f32 v36, v36, s28, -v120
    v_fma_f32 v37, v37, s28, -v120
    v_exp_f32 v34, v34
    v_exp_f32 v35, v35
    v_add_f32 v125, v125, v32
    v_add_f32 v126, v126, v33
    v_cvt_pk_bf16_f32 v32, v32, v33
    v_mfma_f32_32x32x16_bf16 v[16:31], a[32:35], v[80:83], 0
    v_fma_f32 v38, v38, s28, -v120
    v_fma_f32 v39, v39, s28, -v120
    v_exp_f32 v36, v36
    v_exp_f32 v37, v37
    v_add_f32 v125, v125, v34
    v_add_f32 v126, v126, v35
    v_cvt_pk_bf16_f32 v33, v34, v35
    v_mfma_f32_32x32x16_bf16 v[16:31], a[36:39], v[84:87], v[16:31]
    v_fma_f32 v40, v40, s28, -v120
    v_fma_f32 v41, v41, s28, -v120
    v_exp_f32 v38, v38
    v_exp_f32 v39, v39
    v_add_f32 v125, v125, v36
    v_add_f32 v126, v126, v37
    v_cvt_pk_bf16_f32 v34, v36, v37
    v_max3_f32 v116, v116, v0, v1
    v_mfma_f32_32x32x16_bf16 v[16:31], a[40:43], v[88:91], v[16:31]
    v_fma_f32 v42, v42, s28, -v120
    v_fma_f32 v43, v43, s28, -v120
    v_exp_f32 v40, v40
    v_exp_f32 v41, v41
    v_add_f32 v125, v125, v38
    v_add_f32 v126, v126, v39
    v_cvt_pk_bf16_f32 v35, v38, v39
    v_max3_f32 v117, v117, v2, v3
    v_mfma_f32_32x32x16_bf16 v[16:31], a[44:47], v[92:95], v[16:31]
    ds_write_b128 v114, v[32:35] offset:4096
    v_fma_f32 v44, v44, s28, -v120
    v_fma_f32 v45, v45, s28, -v120
    v_exp_f32 v42, v42
    v_exp_f32 v43, v43
    v_add_f32 v125, v125, v40
    v_add_f32 v126, v126, v41
    v_cvt_pk_bf16_f32 v40, v40, v41
    v_max3_f32 v116, v116, v4, v5
    v_mfma_f32_32x32x16_bf16 v[16:31], a[48:51], v[96:99], v[16:31]
    v_fma_f32 v46, v46, s28, -v120
    v_fma_f32 v47, v47, s28, -v120
    v_exp_f32 v44, v44
    v_exp_f32 v45, v45
    v_add_f32 v125, v125, v42
    v_add_f32 v126, v126, v43
    v_cvt_pk_bf16_f32 v41, v42, v43
    v_max3_f32 v117, v117, v6, v7
    v_mfma_f32_32x32x16_bf16 v[16:31], a[52:55], v[100:103], v[16:31]
    v_fma_f32 v48, v48, s28, -v120
    v_fma_f32 v49, v49, s28, -v120
    v_exp_f32 v46, v46
    v_exp_f32 v47, v47
    v_add_f32 v125, v125, v44
    v_add_f32 v126, v126, v45
    v_cvt_pk_bf16_f32 v42, v44, v45
    v_max3_f32 v116, v116, v8, v9
    v_mfma_f32_32x32x16_bf16 v[16:31], a[56:59], v[104:107], v[16:31]
    v_fma_f32 v50, v50, s28, -v120
    v_fma_f32 v51, v51, s28, -v120
    v_exp_f32 v48, v48
    v_exp_f32 v49, v49
    v_add_f32 v125, v125, v46
    v_add_f32 v126, v126, v47
    v_cvt_pk_bf16_f32 v43, v46, v47
    v_max3_f32 v117, v117, v10, v11
    v_mfma_f32_32x32x16_bf16 v[16:31], a[60:63], v[108:111], v[16:31]
    ds_write_b128 v114, v[40:43] offset:5120
    v_fma_f32 v52, v52, s28, -v120
    v_fma_f32 v53, v53, s28, -v120
    v_exp_f32 v50, v50
    v_exp_f32 v51, v51
    v_add_f32 v125, v125, v48
    v_add_f32 v126, v126, v49
    v_cvt_pk_bf16_f32 v48, v48, v49
    v_max3_f32 v116, v116, v12, v13
    v_mfma_f32_32x32x16_bf16 v[32:47], a[64:67], v[80:83], 0
    ds_read_b128 v[80:83], v112 offset:0
    v_fma_f32 v54, v54, s28, -v120
    v_fma_f32 v55, v55, s28, -v120
    v_exp_f32 v52, v52
    v_exp_f32 v53, v53
    v_mfma_f32_32x32x16_bf16 v[32:47], a[68:71], v[84:87], v[32:47]
    ds_read_b128 v[84:87], v113 offset:0
    v_add_f32 v125, v125, v50
    v_add_f32 v126, v126, v51
    v_cvt_pk_bf16_f32 v49, v50, v51
    v_max3_f32 v117, v117, v14, v15
    v_mfma_f32_32x32x16_bf16 v[32:47], a[72:75], v[88:91], v[32:47]
    ds_read_b128 v[88:91], v112 offset:1024
    v_fma_f32 v56, v56, s28, -v120
    v_fma_f32 v57, v57, s28, -v120
    v_exp_f32 v54, v54
    v_exp_f32 v55, v55
    v_mfma_f32_32x32x16_bf16 v[32:47], a[76:79], v[92:95], v[32:47]
    ds_read_b128 v[92:95], v113 offset:1024
    v_add_f32 v125, v125, v52
    v_add_f32 v126, v126, v53
    v_cvt_pk_bf16_f32 v50, v52, v53
    v_max3_f32 v116, v116, v16, v17
    v_max3_f32 v117, v117, v18, v19
    v_mfma_f32_32x32x16_bf16 v[32:47], a[80:83], v[96:99], v[32:47]
    ds_read_b128 v[96:99], v112 offset:2048
    v_fma_f32 v58, v58, s28, -v120
    v_fma_f32 v59, v59, s28, -v120
    v_exp_f32 v56, v56
    v_exp_f32 v57, v57
    v_mfma_f32_32x32x16_bf16 v[32:47], a[84:87], v[100:103], v[32:47]
    ds_read_b128 v[100:103], v113 offset:2048
    v_add_f32 v125, v125, v54
    v_add_f32 v126, v126, v55
    v_cvt_pk_bf16_f32 v51, v54, v55
    v_max3_f32 v116, v116, v20, v21
    v_max3_f32 v117, v117, v22, v23
    v_mfma_f32_32x32x16_bf16 v[32:47], a[88:91], v[104:107], v[32:47]
    ds_read_b128 v[104:107], v112 offset:3072
    ds_write_b128 v114, v[48:51] offset:6144
    v_fma_f32 v60, v60, s28, -v120
    v_fma_f32 v61, v61, s28, -v120
    v_exp_f32 v58, v58
    v_exp_f32 v59, v59
    v_mfma_f32_32x32x16_bf16 v[32:47], a[92:95], v[108:111], v[32:47]
    ds_read_b128 v[108:111], v113 offset:3072
    v_add_f32 v125, v125, v56
    v_add_f32 v126, v126, v57
    v_cvt_pk_bf16_f32 v56, v56, v57
    v_max3_f32 v116, v116, v24, v25
    v_max3_f32 v117, v117, v26, v27
    v_fma_f32 v62, v62, s28, -v120
    v_fma_f32 v63, v63, s28, -v120
    v_exp_f32 v60, v60
    v_exp_f32 v61, v61
    v_add_f32 v125, v125, v58
    v_add_f32 v126, v126, v59
    v_cvt_pk_bf16_f32 v57, v58, v59
    v_max3_f32 v116, v116, v28, v29
    v_max3_f32 v117, v117, v30, v31
    v_exp_f32 v62, v62
    v_exp_f32 v63, v63
    v_add_f32 v125, v125, v60
    v_add_f32 v126, v126, v61
    v_cvt_pk_bf16_f32 v58, v60, v61
    v_max3_f32 v116, v116, v32, v33
    v_max3_f32 v117, v117, v34, v35
    v_max3_f32 v116, v116, v36, v37
    v_max3_f32 v117, v117, v38, v39
    v_max3_f32 v116, v116, v40, v41
    v_max3_f32 v117, v117, v42, v43
    v_max3_f32 v116, v116, v44, v45
    v_max3_f32 v117, v117, v46, v47
    v_max_f32 v116, v116, v117
    ds_write_b32 v115, v116 offset:3072
    s_waitcnt lgkmcnt(0)
    s_barrier
    ds_read_b128 v[120:123], v124 offset:3088
    ds_read_b128 v[116:119], v124 offset:3072
    v_add_f32 v125, v125, v62
    v_add_f32 v126, v126, v63
    v_cvt_pk_bf16_f32 v59, v62, v63
    ds_write_b128 v114, v[56:59] offset:7168
    v_add_f32 v125, v125, v126
    ds_write_b32 v115, v125 offset:0
    s_add_u32 s43, s43, s46
    s_cmp_eq_u32 s43, 0x18000
    s_cselect_b32 s44, 0xffff0000, s46
    s_cselect_b32 s43, 0, s43
    v_add_u32 v114, s44, v114
    s_waitcnt lgkmcnt(3)
    v_max3_f32 v120, v120, v121, v122
    s_waitcnt lgkmcnt(2)
    v_max3_f32 v116, v116, v117, v118
    v_max3_f32 v120, v120, v123, v119
    v_max_f32 v116, v116, v120
    v_mul_f32 v120, s28, v116
    v_fma_f32 v0, v0, s28, -v120
    v_fma_f32 v1, v1, s28, -v120
    v_fma_f32 v2, v2, s28, -v120
    v_fma_f32 v3, v3, s28, -v120
    v_exp_f32 v0, v0
    v_exp_f32 v1, v1
    v_fma_f32 v4, v4, s28, -v120
    v_fma_f32 v5, v5, s28, -v120
    v_exp_f32 v2, v2
    v_exp_f32 v3, v3
    v_mov_b32 v125, v0
    v_mov_b32 v126, v1
    v_cvt_pk_bf16_f32 v0, v0, v1
    v_fma_f32 v6, v6, s28, -v120
    v_fma_f32 v7, v7, s28, -v120
    v_exp_f32 v4, v4
    v_exp_f32 v5, v5
    v_add_f32 v125, v125, v2
    v_add_f32 v126, v126, v3
    v_cvt_pk_bf16_f32 v1, v2, v3
    v_fma_f32 v8, v8, s28, -v120
    v_fma_f32 v9, v9, s28, -v120
    v_exp_f32 v6, v6
    v_exp_f32 v7, v7
    v_add_f32 v125, v125, v4
    v_add_f32 v126, v126, v5
    v_cvt_pk_bf16_f32 v2, v4, v5
    v_fma_f32 v10, v10, s28, -v120
    v_fma_f32 v11, v11, s28, -v120
    v_exp_f32 v8, v8
    v_exp_f32 v9, v9
    v_add_f32 v125, v125, v6
    v_add_f32 v126, v126, v7
    v_cvt_pk_bf16_f32 v3, v6, v7
    ds_write_b128 v114, v[0:3] offset:0
    v_fma_f32 v12, v12, s28, -v120
    v_fma_f32 v13, v13, s28, -v120
    v_exp_f32 v10, v10
    v_exp_f32 v11, v11
    v_add_f32 v125, v125, v8
    v_add_f32 v126, v126, v9
    v_cvt_pk_bf16_f32 v8, v8, v9
    v_fma_f32 v14, v14, s28, -v120
    v_fma_f32 v15, v15, s28, -v120
    v_exp_f32 v12, v12
    v_exp_f32 v13, v13
    v_add_f32 v125, v125, v10
    v_add_f32 v126, v126, v11
    v_cvt_pk_bf16_f32 v9, v10, v11
    v_fma_f32 v16, v16, s28, -v120
    v_fma_f32 v17, v17, s28, -v120
    v_exp_f32 v14, v14
    v_exp_f32 v15, v15
    v_add_f32 v125, v125, v12
    v_add_f32 v126, v126, v13
    v_cvt_pk_bf16_f32 v10, v12, v13
    v_fma_f32 v18, v18, s28, -v120
    v_fma_f32 v19, v19, s28, -v120
    v_exp_f32 v16, v16
    v_exp_f32 v17, v17
    v_add_f32 v125, v125, v14
    v_add_f32 v126, v126, v15
    v_cvt_pk_bf16_f32 v11, v14, v15
    ds_write_b128 v114, v[8:11] offset:1024
    v_fma_f32 v20, v20, s28, -v120
    v_fma_f32 v21, v21, s28, -v120
    v_exp_f32 v18, v18
    v_exp_f32 v19, v19
    v_add_f32 v125, v125, v16
    v_add_f32 v126, v126, v17
    v_cvt_pk_bf16_f32 v16, v16, v17
    v_fma_f32 v22, v22, s28, -v120
    v_fma_f32 v23, v23, s28, -v120
    v_exp_f32 v20, v20
    v_exp_f32 v21, v21
    v_add_f32 v125, v125, v18
    v_add_f32 v126, v126, v19
    v_cvt_pk_bf16_f32 v17, v18, v19
    v_fma_f32 v24, v24, s28, -v120
    v_fma_f32 v25, v25, s28, -v120
    v_exp_f32 v22, v22
    v_exp_f32 v23, v23
    v_add_f32 v125, v125, v20
    v_add_f32 v126, v126, v21
    v_cvt_pk_bf16_f32 v18, v20, v21
    v_fma_f32 v26, v26, s28, -v120
    v_fma_f32 v27, v27, s28, -v120
    v_exp_f32 v24, v24
    v_exp_f32 v25, v25
    v_add_f32 v125, v125, v22
    v_add_f32 v126, v126, v23
    v_cvt_pk_bf16_f32 v19, v22, v23
    ds_write_b128 v114, v[16:19] offset:2048
    v_fma_f32 v28, v28, s28, -v120
    v_fma_f32 v29, v29, s28, -v120
    v_exp_f32 v26, v26
    v_exp_f32 v27, v27
    v_add_f32 v125, v125, v24
    v_add_f32 v126, v126, v25
    v_cvt_pk_bf16_f32 v24, v24, v25
    v_fma_f32 v30, v30, s28, -v120
    v_fma_f32 v31, v31, s28, -v120
    v_exp_f32 v28, v28
    v_exp_f32 v29, v29
    v_add_f32 v125, v125, v26
    v_add_f32 v126, v126, v27
    v_cvt_pk_bf16_f32 v25, v26, v27
    v_fma_f32 v32, v32, s28, -v120
    v_fma_f32 v33, v33, s28, -v120
    v_exp_f32 v30, v30
    v_exp_f32 v31, v31
    v_add_f32 v125, v125, v28
    v_add_f32 v126, v126, v29
    v_cvt_pk_bf16_f32 v26, v28, v29
    v_fma_f32 v34, v34, s28, -v120
    v_fma_f32 v35, v35, s28, -v120
    v_exp_f32 v32, v32
    v_exp_f32 v33, v33
    v_add_f32 v125, v125, v30
    v_add_f32 v126, v126, v31
    v_cvt_pk_bf16_f32 v27, v30, v31
    ds_write_b128 v114, v[24:27] offset:3072
    v_fma_f32 v36, v36, s28, -v120
    v_fma_f32 v37, v37, s28, -v120
    v_exp_f32 v34, v34
    v_exp_f32 v35, v35
    v_add_f32 v125, v125, v32
    v_add_f32 v126, v126, v33
    v_cvt_pk_bf16_f32 v32, v32, v33
    v_fma_f32 v38, v38, s28, -v120
    v_fma_f32 v39, v39, s28, -v120
    v_exp_f32 v36, v36
    v_exp_f32 v37, v37
    v_add_f32 v125, v125, v34
    v_add_f32 v126, v126, v35
    v_cvt_pk_bf16_f32 v33, v34, v35
    v_fma_f32 v40, v40, s28, -v120
    v_fma_f32 v41, v41, s28, -v120
    v_exp_f32 v38, v38
    v_exp_f32 v39, v39
    v_add_f32 v125, v125, v36
    v_add_f32 v126, v126, v37
    v_cvt_pk_bf16_f32 v34, v36, v37
    v_fma_f32 v42, v42, s28, -v120
    v_fma_f32 v43, v43, s28, -v120
    v_exp_f32 v40, v40
    v_exp_f32 v41, v41
    v_add_f32 v125, v125, v38
    v_add_f32 v126, v126, v39
    v_cvt_pk_bf16_f32 v35, v38, v39
    ds_write_b128 v114, v[32:35] offset:4096
    v_fma_f32 v44, v44, s28, -v120
    v_fma_f32 v45, v45, s28, -v120
    v_exp_f32 v42, v42
    v_exp_f32 v43, v43
    v_add_f32 v125, v125, v40
    v_add_f32 v126, v126, v41
    v_cvt_pk_bf16_f32 v40, v40, v41
    v_fma_f32 v46, v46, s28, -v120
    v_fma_f32 v47, v47, s28, -v120
    v_exp_f32 v44, v44
    v_exp_f32 v45, v45
    v_add_f32 v125, v125, v42
    v_add_f32 v126, v126, v43
    v_cvt_pk_bf16_f32 v41, v42, v43
    v_fma_f32 v64, v64, s28, -v120
    v_fma_f32 v65, v65, s28, -v120
    v_exp_f32 v46, v46
    v_exp_f32 v47, v47
    v_add_f32 v125, v125, v44
    v_add_f32 v126, v126, v45
    v_cvt_pk_bf16_f32 v42, v44, v45
    v_fma_f32 v66, v66, s28, -v120
    v_fma_f32 v67, v67, s28, -v120
    v_exp_f32 v64, v64
    v_exp_f32 v65, v65
    v_add_f32 v125, v125, v46
    v_add_f32 v126, v126, v47
    v_cvt_pk_bf16_f32 v43, v46, v47
    ds_write_b128 v114, v[40:43] offset:5120
    v_fma_f32 v68, v68, s28, -v120
    v_fma_f32 v69, v69, s28, -v120
    v_exp_f32 v66, v66
    v_exp_f32 v67, v67
    v_add_f32 v125, v125, v64
    v_add_f32 v126, v126, v65
    v_cvt_pk_bf16_f32 v64, v64, v65
    v_fma_f32 v70, v70, s28, -v120
    v_fma_f32 v71, v71, s28, -v120
    v_exp_f32 v68, v68
    v_exp_f32 v69, v69
    v_add_f32 v125, v125, v66
    v_add_f32 v126, v126, v67
    v_cvt_pk_bf16_f32 v65, v66, v67
    v_fma_f32 v72, v72, s28, -v120
    v_fma_f32 v73, v73, s28, -v120
    v_exp_f32 v70, v70
    v_exp_f32 v71, v71
    v_add_f32 v125, v125, v68
    v_add_f32 v126, v126, v69
    v_cvt_pk_bf16_f32 v66, v68, v69
    v_fma_f32 v74, v74, s28, -v120
    v_fma_f32 v75, v75, s28, -v120
    v_exp_f32 v72, v72
    v_exp_f32 v73, v73
    v_add_f32 v125, v125, v70
    v_add_f32 v126, v126, v71
    v_cvt_pk_bf16_f32 v67, v70, v71
    ds_write_b128 v114, v[64:67] offset:6144
    v_fma_f32 v76, v76, s28, -v120
    v_fma_f32 v77, v77, s28, -v120
    v_exp_f32 v74, v74
    v_exp_f32 v75, v75
    v_add_f32 v125, v125, v72
    v_add_f32 v126, v126, v73
    v_cvt_pk_bf16_f32 v72, v72, v73
    v_fma_f32 v78, v78, s28, -v120
    v_fma_f32 v79, v79, s28, -v120
    v_exp_f32 v76, v76
    v_exp_f32 v77, v77
    v_add_f32 v125, v125, v74
    v_add_f32 v126, v126, v75
    v_cvt_pk_bf16_f32 v73, v74, v75
    v_exp_f32 v78, v78
    v_exp_f32 v79, v79
    v_add_f32 v125, v125, v76
    v_add_f32 v126, v126, v77
    v_cvt_pk_bf16_f32 v74, v76, v77
    s_waitcnt lgkmcnt(0)
    s_barrier
    v_add_f32 v125, v125, v78
    v_add_f32 v126, v126, v79
    v_cvt_pk_bf16_f32 v75, v78, v79
    ds_write_b128 v114, v[72:75] offset:7168
    v_add_f32 v125, v125, v126
    ds_write_b32 v115, v125 offset:1024
    s_add_u32 s43, s43, s46
    s_cmp_eq_u32 s43, 0x18000
    s_cselect_b32 s44, 0xffff0000, s46
    s_cselect_b32 s43, 0, s43
    v_add_u32 v114, s44, v114
    s_waitcnt lgkmcnt(0)
    s_barrier
    s_endpgm
L_consumer:
    v_and_b32 v1, 31, v0
    v_lshrrev_b32 v2, 5, v0
    v_lshrrev_b32 v3, 2, v0
    v_and_b32 v4, 3, v0
    v_lshrrev_b32 v5, 4, v0
    v_xor_b32 v5, v5, v4
    v_lshlrev_b32 v109, 8, v3
    v_lshl_add_u32 v109, v5, 4, v109
    s_lshr_b32 s32, s30, 1
    s_lshl_b32 s39, s32, 12
    s_and_b32 s32, s30, 1
    s_lshl_b32 s32, s32, 7
    s_add_u32 s39, s39, s32
    s_lshl_b32 s37, s30, 11
    s_add_u32 s37, s37, 98304
    s_mov_b32 s36, 4294901760
    s_add_u32 m0, s37, s36
    s_add_u32 s32, s37, s36
    buffer_load_dwordx4 v109, s[12:15], s39 offen offset:0 nt lds
    s_add_u32 m0, s32, 960
    s_add_u32 s33, s36, 8192
    buffer_load_dwordx4 v109, s[12:15], s39 offen offset:64 nt lds
    s_add_u32 s39, s39, 8192
    s_movk_i32 s36, 0x2000
    s_add_u32 m0, s37, s36
    s_add_u32 s32, s37, s36
    buffer_load_dwordx4 v109, s[12:15], s39 offen offset:0 nt lds
    s_add_u32 m0, s32, 960
    s_add_u32 s33, s36, 8192
    buffer_load_dwordx4 v109, s[12:15], s39 offen offset:64 nt lds
    s_add_u32 s39, s39, 8192
    s_and_b32 s36, s33, 0x7fff
    s_add_u32 m0, s37, s36
    s_add_u32 s32, s37, s36
    buffer_load_dwordx4 v109, s[12:15], s39 offen offset:0 nt lds
    s_add_u32 m0, s32, 960
    s_add_u32 s33, s36, 8192
    buffer_load_dwordx4 v109, s[12:15], s39 offen offset:64 nt lds
    s_add_u32 s39, s39, 8192
    s_and_b32 s36, s33, 0x7fff
    s_add_u32 m0, s37, s36
    s_add_u32 s32, s37, s36
    buffer_load_dwordx4 v109, s[12:15], s39 offen offset:0 nt lds
    s_add_u32 m0, s32, 960
    s_add_u32 s33, s36, 8192
    buffer_load_dwordx4 v109, s[12:15], s39 offen offset:64 nt lds
    s_add_u32 s39, s39, 8192
    s_and_b32 s36, s33, 0x7fff
    s_add_u32 m0, s37, s36
    s_add_u32 s32, s37, s36
    buffer_load_dwordx4 v109, s[12:15], s39 offen offset:0 nt lds
    s_add_u32 m0, s32, 960
    s_add_u32 s33, s36, 8192
    buffer_load_dwordx4 v109, s[12:15], s39 offen offset:64 nt lds
    s_add_u32 s39, s39, 8192
    s_and_b32 s36, s33, 0x7fff
    s_barrier
    v_mov_b32 v114, 145408
    v_mov_b32 v6, 0
    v_mov_b32 v7, 0
    v_mov_b32 v8, 0
    v_mov_b32 v9, 0
    ds_write_b128 v114, v[6:9]
    s_lshl_b32 s33, s30, 6
    v_lshlrev_b32 v106, 4, v0
    v_lshlrev_b32 v107, 5, v1
    v_add_u32 v107, 131072, v107
    s_mov_b32 s38, 0
    s_mov_b32 s43, 0
    v_lshlrev_b32 v108, 8, v3
    v_lshl_add_u32 v108, v4, 4, v108
    v_add_u32 v108, s33, v108
    s_mul_i32 s34, s30, 2560
    s_add_u32 s34, s34, 135168
    v_add_u32 v112, s34, v106
    v_bfe_u32 v5, v0, 2, 2
    v_lshl_add_u32 v5, v2, 2, v5
    v_lshlrev_b32 v113, 6, v5
    v_bfe_u32 v5, v0, 4, 1
    v_lshl_add_u32 v113, v5, 5, v113
    v_lshl_add_u32 v113, v4, 3, v113
    v_add_u32 v113, s34, v113
    v_mul_u32_u24 v110, 80, v1
    v_lshl_add_u32 v110, v2, 3, v110
    v_add_u32 v110, s34, v110
    v_mul_u32_u24 v111, 80, v3
    v_lshl_add_u32 v111, v4, 4, v111
    v_add_u32 v111, s34, v111
    s_waitcnt vmcnt(0) lgkmcnt(0)
    s_barrier
    s_mov_b32 s33, 0
    buffer_load_dwordx4 a[0:3], v108, s[20:23], s33 offen offset:0 nt
    s_mov_b32 s33, 4096
    buffer_load_dwordx4 a[4:7], v108, s[20:23], s33 offen offset:0 nt
    s_mov_b32 s33, 8192
    buffer_load_dwordx4 a[8:11], v108, s[20:23], s33 offen offset:0 nt
    s_mov_b32 s33, 12288
    buffer_load_dwordx4 a[12:15], v108, s[20:23], s33 offen offset:0 nt
    s_mov_b32 s33, 16384
    buffer_load_dwordx4 a[16:19], v108, s[20:23], s33 offen offset:0 nt
    s_mov_b32 s33, 20480
    buffer_load_dwordx4 a[20:23], v108, s[20:23], s33 offen offset:0 nt
    s_mov_b32 s33, 24576
    buffer_load_dwordx4 a[24:27], v108, s[20:23], s33 offen offset:0 nt
    s_mov_b32 s33, 32768
    buffer_load_dwordx4 a[32:35], v108, s[20:23], s33 offen offset:0 nt
    s_mov_b32 s33, 36864
    buffer_load_dwordx4 a[36:39], v108, s[20:23], s33 offen offset:0 nt
    s_mov_b32 s33, 40960
    buffer_load_dwordx4 a[40:43], v108, s[20:23], s33 offen offset:0 nt
    s_mov_b32 s33, 45056
    buffer_load_dwordx4 a[44:47], v108, s[20:23], s33 offen offset:0 nt
    s_mov_b32 s33, 49152
    buffer_load_dwordx4 a[48:51], v108, s[20:23], s33 offen offset:0 nt
    s_mov_b32 s33, 53248
    buffer_load_dwordx4 a[52:55], v108, s[20:23], s33 offen offset:0 nt
    s_mov_b32 s33, 57344
    buffer_load_dwordx4 a[56:59], v108, s[20:23], s33 offen offset:0 nt
    s_mov_b32 s33, 65536
    buffer_load_dwordx4 a[64:67], v108, s[20:23], s33 offen offset:0 nt
    s_mov_b32 s33, 69632
    buffer_load_dwordx4 a[68:71], v108, s[20:23], s33 offen offset:0 nt
    s_mov_b32 s33, 73728
    buffer_load_dwordx4 a[72:75], v108, s[20:23], s33 offen offset:0 nt
    s_mov_b32 s33, 77824
    buffer_load_dwordx4 a[76:79], v108, s[20:23], s33 offen offset:0 nt
    s_mov_b32 s33, 81920
    buffer_load_dwordx4 a[80:83], v108, s[20:23], s33 offen offset:0 nt
    s_mov_b32 s33, 86016
    buffer_load_dwordx4 a[84:87], v108, s[20:23], s33 offen offset:0 nt
    s_mov_b32 s33, 90112
    buffer_load_dwordx4 a[88:91], v108, s[20:23], s33 offen offset:0 nt
    s_mov_b32 s33, 98304
    buffer_load_dwordx4 a[96:99], v108, s[20:23], s33 offen offset:0 nt
    s_mov_b32 s33, 102400
    buffer_load_dwordx4 a[100:103], v108, s[20:23], s33 offen offset:0 nt
    s_mov_b32 s33, 106496
    buffer_load_dwordx4 a[104:107], v108, s[20:23], s33 offen offset:0 nt
    s_mov_b32 s33, 110592
    buffer_load_dwordx4 a[108:111], v108, s[20:23], s33 offen offset:0 nt
    s_mov_b32 s33, 114688
    buffer_load_dwordx4 a[112:115], v108, s[20:23], s33 offen offset:0 nt
    s_mov_b32 s33, 118784
    buffer_load_dwordx4 a[116:119], v108, s[20:23], s33 offen offset:0 nt
    s_mov_b32 s33, 122880
    buffer_load_dwordx4 a[120:123], v108, s[20:23], s33 offen offset:0 nt
    s_mov_b32 s33, 28672
    buffer_load_dwordx4 a[28:31], v108, s[20:23], s33 offen offset:0 nt
    s_mov_b32 s33, 61440
    buffer_load_dwordx4 a[60:63], v108, s[20:23], s33 offen offset:0 nt
    s_mov_b32 s33, 94208
    buffer_load_dwordx4 a[92:95], v108, s[20:23], s33 offen offset:0 nt
    s_mov_b32 s33, 126976
    buffer_load_dwordx4 a[124:127], v108, s[20:23], s33 offen offset:0 nt
L_csync1:
    ds_read_b32 v96, v114 offset:4
    s_waitcnt lgkmcnt(0)
    v_readfirstlane_b32 s32, v96
    s_sub_u32 s49, s49, 1
    s_cselect_b32 s32, 256, s32
    s_cmp_lt_u32 s32, 256
    s_cbranch_scc1 L_csync1
    ds_read_b128 v[32:35], v106 offset:0
    ds_read_b128 v[36:39], v106 offset:1024
    ds_read_b128 v[40:43], v106 offset:2048
    ds_read_b128 v[44:47], v106 offset:3072
    ds_read_b128 v[48:51], v106 offset:4096
    ds_read_b128 v[52:55], v106 offset:5120
    ds_read_b128 v[56:59], v106 offset:6144
    ds_read_b128 v[60:63], v106 offset:8192
    s_waitcnt vmcnt(31)
    ds_write_b128 v112, a[0:3] offset:0
    ds_read_b64_tr_b16 a[0:1], v113 offset:0
    ds_read_b64_tr_b16 a[2:3], v113 offset:512
    s_waitcnt vmcnt(30)
    ds_write_b128 v112, a[4:7] offset:1024
    ds_read_b64_tr_b16 a[4:5], v113 offset:1024
    ds_read_b64_tr_b16 a[6:7], v113 offset:1536
    s_waitcnt vmcnt(29)
    ds_write_b128 v112, a[8:11] offset:0
    ds_read_b64_tr_b16 a[8:9], v113 offset:0
    ds_read_b64_tr_b16 a[10:11], v113 offset:512
    s_waitcnt vmcnt(28)
    ds_write_b128 v112, a[12:15] offset:1024
    ds_read_b64_tr_b16 a[12:13], v113 offset:1024
    ds_read_b64_tr_b16 a[14:15], v113 offset:1536
    s_waitcnt lgkmcnt(9)
    v_mfma_f32_32x32x16_bf16 v[0:15], a[0:3], v[32:35], 0
    ds_read_b128 v[32:35], v106 offset:9216
    s_add_u32 m0, s37, s36
    s_add_u32 s32, s37, s36
    s_waitcnt vmcnt(27)
    ds_write_b128 v112, a[16:19] offset:0
    ds_read_b64_tr_b16 a[16:17], v113 offset:0
    ds_read_b64_tr_b16 a[18:19], v113 offset:512
    s_waitcnt lgkmcnt(10)
    v_mfma_f32_32x32x16_bf16 v[0:15], a[4:7], v[36:39], v[0:15]
    ds_read_b128 v[36:39], v106 offset:10240
    buffer_load_dwordx4 v109, s[12:15], s39 offen offset:0 nt lds
    s_add_u32 m0, s32, 960
    s_waitcnt vmcnt(27)
    ds_write_b128 v112, a[20:23] offset:1024
    ds_read_b64_tr_b16 a[20:21], v113 offset:1024
    ds_read_b64_tr_b16 a[22:23], v113 offset:1536
    s_waitcnt lgkmcnt(11)
    v_mfma_f32_32x32x16_bf16 v[0:15], a[8:11], v[40:43], v[0:15]
    ds_read_b128 v[40:43], v106 offset:11264
    s_add_u32 s33, s36, 8192
    buffer_load_dwordx4 v109, s[12:15], s39 offen offset:64 nt lds
    s_waitcnt vmcnt(27)
    ds_write_b128 v112, a[24:27] offset:0
    ds_read_b64_tr_b16 a[24:25], v113 offset:0
    ds_read_b64_tr_b16 a[26:27], v113 offset:512
    s_waitcnt lgkmcnt(12)
    v_mfma_f32_32x32x16_bf16 v[0:15], a[12:15], v[44:47], v[0:15]
    ds_read_b128 v[44:47], v106 offset:12288
    s_add_u32 s39, s39, 8192
    s_and_b32 s36, s33, 0x7fff
    s_waitcnt vmcnt(26)
    ds_write_b128 v112, a[32:35] offset:1024
    ds_read_b64_tr_b16 a[32:33], v113 offset:1024
    ds_read_b64_tr_b16 a[34:35], v113 offset:1536
    s_waitcnt lgkmcnt(12)
    v_mfma_f32_32x32x16_bf16 v[0:15], a[16:19], v[48:51], v[0:15]
    ds_read_b128 v[48:51], v106 offset:13312
    s_waitcnt vmcnt(25)
    ds_write_b128 v112, a[36:39] offset:0
    ds_read_b64_tr_b16 a[36:37], v113 offset:0
    ds_read_b64_tr_b16 a[38:39], v113 offset:512
    s_waitcnt lgkmcnt(12)
    v_mfma_f32_32x32x16_bf16 v[0:15], a[20:23], v[52:55], v[0:15]
    ds_read_b128 v[52:55], v106 offset:14336
    s_waitcnt vmcnt(24)
    ds_write_b128 v112, a[40:43] offset:1024
    ds_read_b64_tr_b16 a[40:41], v113 offset:1024
    ds_read_b64_tr_b16 a[42:43], v113 offset:1536
    s_waitcnt lgkmcnt(12)
    v_mfma_f32_32x32x16_bf16 v[0:15], a[24:27], v[56:59], v[0:15]
    ds_read_b128 v[56:59], v106 offset:16384
    s_waitcnt vmcnt(23)
    ds_write_b128 v112, a[44:47] offset:0
    ds_read_b64_tr_b16 a[44:45], v113 offset:0
    ds_read_b64_tr_b16 a[46:47], v113 offset:512
    s_waitcnt lgkmcnt(12)
    v_mfma_f32_32x32x16_bf16 v[0:15], a[32:35], v[60:63], v[0:15]
    ds_read_b128 v[60:63], v106 offset:17408
L_csync2:
    ds_read_b32 v96, v114 offset:8
    s_waitcnt lgkmcnt(0)
    v_readfirstlane_b32 s32, v96
    s_sub_u32 s49, s49, 1
    s_cselect_b32 s32, 256, s32
    s_cmp_lt_u32 s32, 256
    s_cbranch_scc1 L_csync2
    s_waitcnt vmcnt(22)
    ds_write_b128 v112, a[48:51] offset:1024
    ds_read_b64_tr_b16 a[48:49], v113 offset:1024
    ds_read_b64_tr_b16 a[50:51], v113 offset:1536
    v_mfma_f32_32x32x16_bf16 v[0:15], a[36:39], v[32:35], v[0:15]
    ds_read_b128 v[32:35], v106 offset:32768
    s_waitcnt vmcnt(21)
    ds_write_b128 v112, a[52:55] offset:0
    ds_read_b64_tr_b16 a[52:53], v113 offset:0
    ds_read_b64_tr_b16 a[54:55], v113 offset:512
    v_mfma_f32_32x32x16_bf16 v[0:15], a[40:43], v[36:39], v[0:15]
    ds_read_b128 v[36:39], v106 offset:33792
    s_waitcnt vmcnt(20)
    ds_write_b128 v112, a[56:59] offset:1024
    ds_read_b64_tr_b16 a[56:57], v113 offset:1024
    ds_read_b64_tr_b16 a[58:59], v113 offset:1536
    v_mfma_f32_32x32x16_bf16 v[0:15], a[44:47], v[40:43], v[0:15]
    ds_read_b128 v[40:43], v106 offset:34816
    s_waitcnt vmcnt(19)
    ds_write_b128 v112, a[64:67] offset:0
    ds_read_b64_tr_b16 a[64:65], v113 offset:0
    ds_read_b64_tr_b16 a[66:67], v113 offset:512
    s_waitcnt lgkmcnt(12)
    v_mfma_f32_32x32x16_bf16 v[0:15], a[48:51], v[44:47], v[0:15]
    ds_read_b128 v[44:47], v106 offset:35840
    s_waitcnt vmcnt(18)
    ds_write_b128 v112, a[68:71] offset:1024
    ds_read_b64_tr_b16 a[68:69], v113 offset:1024
    ds_read_b64_tr_b16 a[70:71], v113 offset:1536
    s_waitcnt lgkmcnt(12)
    v_mfma_f32_32x32x16_bf16 v[0:15], a[52:55], v[48:51], v[0:15]
    ds_read_b128 v[48:51], v106 offset:36864
    s_waitcnt lgkmcnt(9)
    v_mfma_f32_32x32x16_bf16 v[0:15], a[56:59], v[52:55], v[0:15]
    ds_read_b128 v[52:55], v106 offset:37888
    s_waitcnt lgkmcnt(6)
    v_mfma_f32_32x32x16_bf16 v[0:15], a[64:67], v[56:59], v[0:15]
    ds_read_b128 v[56:59], v106 offset:38912
    s_waitcnt lgkmcnt(3)
    v_mfma_f32_32x32x16_bf16 v[0:15], a[68:71], v[60:63], v[0:15]
    ds_read_b128 v[60:63], v106 offset:40960
    v_mfma_f32_32x32x16_bf16 v[16:31], a[0:3], v[32:35], 0
    ds_read_b128 v[32:35], v106 offset:41984
    ds_read_b128 v[96:99], v107 offset:0
    ds_read_b128 v[100:103], v107 offset:16
    v_mfma_f32_32x32x16_bf16 v[16:31], a[4:7], v[36:39], v[16:31]
    ds_read_b128 v[36:39], v106 offset:43008
    s_waitcnt lgkmcnt(2)
    v_add_f32 v96, v96, v97
    v_add_f32 v98, v98, v99
    v_mfma_f32_32x32x16_bf16 v[16:31], a[8:11], v[40:43], v[16:31]
    ds_read_b128 v[40:43], v106 offset:44032
    s_waitcnt lgkmcnt(2)
    v_add_f32 v100, v100, v101
    v_add_f32 v102, v102, v103
    v_mfma_f32_32x32x16_bf16 v[16:31], a[12:15], v[44:47], v[16:31]
    ds_read_b128 v[44:47], v106 offset:45056
    v_add_f32 v96, v96, v98
    v_add_f32 v100, v100, v102
    v_mfma_f32_32x32x16_bf16 v[16:31], a[16:19], v[48:51], v[16:31]
    ds_read_b128 v[48:51], v106 offset:46080
    v_add_f32 v96, v96, v100
    v_rcp_f32 v104, v96
    v_mfma_f32_32x32x16_bf16 v[16:31], a[20:23], v[52:55], v[16:31]
    ds_read_b128 v[52:55], v106 offset:47104
    s_add_u32 m0, s37, s36
    s_add_u32 s32, s37, s36
    v_mfma_f32_32x32x16_bf16 v[16:31], a[24:27], v[56:59], v[16:31]
    ds_read_b128 v[56:59], v106 offset:49152
    buffer_load_dwordx4 v109, s[12:15], s39 offen offset:0 nt lds
    s_add_u32 m0, s32, 960
    v_mfma_f32_32x32x16_bf16 v[16:31], a[32:35], v[60:63], v[16:31]
    ds_read_b128 v[60:63], v106 offset:50176
    s_add_u32 s33, s36, 8192
    buffer_load_dwordx4 v109, s[12:15], s39 offen offset:64 nt lds
    v_mfma_f32_32x32x16_bf16 v[16:31], a[36:39], v[32:35], v[16:31]
    ds_read_b128 v[32:35], v106 offset:18432
    s_add_u32 s39, s39, 8192
    s_and_b32 s36, s33, 0x7fff
    s_waitcnt lgkmcnt(7)
    v_mfma_f32_32x32x16_bf16 v[16:31], a[40:43], v[36:39], v[16:31]
    ds_read_b128 v[36:39], v106 offset:19456
    s_waitcnt lgkmcnt(7)
    v_mfma_f32_32x32x16_bf16 v[16:31], a[44:47], v[40:43], v[16:31]
    ds_read_b128 v[40:43], v106 offset:20480
    s_waitcnt lgkmcnt(7)
    v_mfma_f32_32x32x16_bf16 v[16:31], a[48:51], v[44:47], v[16:31]
    ds_read_b128 v[44:47], v106 offset:21504
    s_waitcnt lgkmcnt(7)
    v_mfma_f32_32x32x16_bf16 v[16:31], a[52:55], v[48:51], v[16:31]
    ds_read_b128 v[48:51], v106 offset:22528
    s_waitcnt vmcnt(19)
    ds_write_b128 v112, a[72:75] offset:0
    ds_read_b64_tr_b16 a[72:73], v113 offset:0
    ds_read_b64_tr_b16 a[74:75], v113 offset:512
    s_waitcnt lgkmcnt(10)
    v_mfma_f32_32x32x16_bf16 v[16:31], a[56:59], v[52:55], v[16:31]
    ds_read_b128 v[52:55], v106 offset:24576
    s_waitcnt vmcnt(18)
    ds_write_b128 v112, a[76:79] offset:1024
    ds_read_b64_tr_b16 a[76:77], v113 offset:1024
    ds_read_b64_tr_b16 a[78:79], v113 offset:1536
    s_waitcnt lgkmcnt(13)
    v_mfma_f32_32x32x16_bf16 v[16:31], a[64:67], v[56:59], v[16:31]
    ds_read_b128 v[56:59], v106 offset:25600
    s_waitcnt vmcnt(17)
    ds_write_b128 v112, a[80:83] offset:0
    ds_read_b64_tr_b16 a[80:81], v113 offset:0
    ds_read_b64_tr_b16 a[82:83], v113 offset:512
    s_waitcnt lgkmcnt(15)
    v_mfma_f32_32x32x16_bf16 v[16:31], a[68:71], v[60:63], v[16:31]
    ds_read_b128 v[60:63], v106 offset:26624
    s_waitcnt vmcnt(16)
    ds_write_b128 v112, a[84:87] offset:1024
    ds_read_b64_tr_b16 a[84:85], v113 offset:1024
    ds_read_b64_tr_b16 a[86:87], v113 offset:1536
    s_waitcnt lgkmcnt(12)
    v_mfma_f32_32x32x16_bf16 v[0:15], a[72:75], v[32:35], v[0:15]
    ds_read_b128 v[32:35], v106 offset:27648
    s_waitcnt vmcnt(15)
    ds_write_b128 v112, a[88:91] offset:0
    ds_read_b64_tr_b16 a[88:89], v113 offset:0
    ds_read_b64_tr_b16 a[90:91], v113 offset:512
    s_waitcnt lgkmcnt(12)
    v_mfma_f32_32x32x16_bf16 v[0:15], a[76:79], v[36:39], v[0:15]
    ds_read_b128 v[36:39], v106 offset:28672
    s_waitcnt vmcnt(14)
    ds_write_b128 v112, a[96:99] offset:1024
    ds_read_b64_tr_b16 a[96:97], v113 offset:1024
    ds_read_b64_tr_b16 a[98:99], v113 offset:1536
    s_waitcnt lgkmcnt(12)
    v_mfma_f32_32x32x16_bf16 v[0:15], a[80:83], v[40:43], v[0:15]
    ds_read_b128 v[40:43], v106 offset:29696
    s_waitcnt vmcnt(13)
    ds_write_b128 v112, a[100:103] offset:0
    ds_read_b64_tr_b16 a[100:101], v113 offset:0
    ds_read_b64_tr_b16 a[102:103], v113 offset:512
    s_waitcnt lgkmcnt(12)
    v_mfma_f32_32x32x16_bf16 v[0:15], a[84:87], v[44:47], v[0:15]
    ds_read_b128 v[44:47], v106 offset:30720
    s_waitcnt vmcnt(12)
    ds_write_b128 v112, a[104:107] offset:1024
    ds_read_b64_tr_b16 a[104:105], v113 offset:1024
    ds_read_b64_tr_b16 a[106:107], v113 offset:1536
    s_waitcnt lgkmcnt(12)
    v_mfma_f32_32x32x16_bf16 v[0:15], a[88:91], v[48:51], v[0:15]
    ds_read_b128 v[48:51], v106 offset:7168
    s_waitcnt vmcnt(11)
    ds_write_b128 v112, a[108:111] offset:0
    ds_read_b64_tr_b16 a[108:109], v113 offset:0
    ds_read_b64_tr_b16 a[110:111], v113 offset:512
    s_waitcnt lgkmcnt(12)
    v_mfma_f32_32x32x16_bf16 v[0:15], a[96:99], v[52:55], v[0:15]
    ds_read_b128 v[52:55], v106 offset:15360
    s_waitcnt vmcnt(10)
    ds_write_b128 v112, a[112:115] offset:1024
    ds_read_b64_tr_b16 a[112:113], v113 offset:1024
    ds_read_b64_tr_b16 a[114:115], v113 offset:1536
    s_waitcnt lgkmcnt(12)
    v_mfma_f32_32x32x16_bf16 v[0:15], a[100:103], v[56:59], v[0:15]
    ds_read_b128 v[56:59], v106 offset:23552
    s_waitcnt vmcnt(9)
    ds_write_b128 v112, a[116:119] offset:0
    ds_read_b64_tr_b16 a[116:117], v113 offset:0
    ds_read_b64_tr_b16 a[118:119], v113 offset:512
    s_waitcnt lgkmcnt(12)
    v_mfma_f32_32x32x16_bf16 v[0:15], a[104:107], v[60:63], v[0:15]
    ds_read_b128 v[60:63], v106 offset:31744
    s_waitcnt vmcnt(8)
    ds_write_b128 v112, a[120:123] offset:1024
    ds_read_b64_tr_b16 a[120:121], v113 offset:1024
    ds_read_b64_tr_b16 a[122:123], v113 offset:1536
    s_waitcnt lgkmcnt(12)
    v_mfma_f32_32x32x16_bf16 v[0:15], a[108:111], v[32:35], v[0:15]
    ds_read_b128 v[32:35], v106 offset:51200
    s_waitcnt vmcnt(7)
    ds_write_b128 v112, a[28:31] offset:0
    ds_read_b64_tr_b16 a[28:29], v113 offset:0
    ds_read_b64_tr_b16 a[30:31], v113 offset:512
    s_waitcnt lgkmcnt(12)
    v_mfma_f32_32x32x16_bf16 v[0:15], a[112:115], v[36:39], v[0:15]
    ds_read_b128 v[36:39], v106 offset:52224
    s_waitcnt vmcnt(6)
    ds_write_b128 v112, a[60:63] offset:1024
    ds_read_b64_tr_b16 a[60:61], v113 offset:1024
    ds_read_b64_tr_b16 a[62:63], v113 offset:1536
    s_waitcnt lgkmcnt(12)
    v_mfma_f32_32x32x16_bf16 v[0:15], a[116:119], v[40:43], v[0:15]
    ds_read_b128 v[40:43], v106 offset:53248
    s_waitcnt vmcnt(5)
    ds_write_b128 v112, a[92:95] offset:0
    ds_read_b64_tr_b16 a[92:93], v113 offset:0
    ds_read_b64_tr_b16 a[94:95], v113 offset:512
    s_waitcnt lgkmcnt(12)
    v_mfma_f32_32x32x16_bf16 v[0:15], a[120:123], v[44:47], v[0:15]
    ds_read_b128 v[44:47], v106 offset:54272
    s_waitcnt vmcnt(4)
    ds_write_b128 v112, a[124:127] offset:1024
    ds_read_b64_tr_b16 a[124:125], v113 offset:1024
    ds_read_b64_tr_b16 a[126:127], v113 offset:1536
    s_waitcnt lgkmcnt(12)
    v_mfma_f32_32x32x16_bf16 v[0:15], a[28:31], v[48:51], v[0:15]
    ds_read_b128 v[48:51], v106 offset:55296
    s_waitcnt lgkmcnt(9)
    v_mfma_f32_32x32x16_bf16 v[0:15], a[60:63], v[52:55], v[0:15]
    ds_read_b128 v[52:55], v106 offset:57344
    s_waitcnt lgkmcnt(6)
    v_mfma_f32_32x32x16_bf16 v[0:15], a[92:95], v[56:59], v[0:15]
    ds_read_b128 v[56:59], v106 offset:58368
    s_waitcnt lgkmcnt(3)
    v_mfma_f32_32x32x16_bf16 v[0:15], a[124:127], v[60:63], v[0:15]
    ds_read_b128 v[60:63], v106 offset:59392
    s_add_u32 s43, s43, s46
    s_cmp_eq_u32 s43, 0x18000
    s_cselect_b32 s44, 0xffff0000, s46
    s_cselect_b32 s43, 0, s43
    v_add_u32 v106, s44, v106
    s_waitcnt vmcnt(2)
    s_nop 0
    s_barrier
    s_mov_b32 s31, 8
L_cloop:
    s_waitcnt lgkmcnt(7)
    v_mfma_f32_32x32x16_bf16 v[16:31], a[72:75], v[32:35], v[16:31]
    ds_read_b128 v[32:35], v106 offset:27648
    v_mul_f32 v0, v104, v0
    v_mul_f32 v1, v104, v1
    v_mul_f32 v2, v104, v2
    s_waitcnt lgkmcnt(7)
    v_mfma_f32_32x32x16_bf16 v[16:31], a[76:79], v[36:39], v[16:31]
    ds_read_b128 v[36:39], v106 offset:28672
    v_mul_f32 v3, v104, v3
    v_mul_f32 v4, v104, v4
    v_mul_f32 v5, v104, v5
    s_waitcnt lgkmcnt(7)
    v_mfma_f32_32x32x16_bf16 v[16:31], a[80:83], v[40:43], v[16:31]
    ds_read_b128 v[40:43], v106 offset:29696
    v_mul_f32 v6, v104, v6
    v_mul_f32 v7, v104, v7
    v_mul_f32 v8, v104, v8
    s_waitcnt lgkmcnt(7)
    v_mfma_f32_32x32x16_bf16 v[16:31], a[84:87], v[44:47], v[16:31]
    ds_read_b128 v[44:47], v106 offset:30720
    v_mul_f32 v9, v104, v9
    v_mul_f32 v10, v104, v10
    v_mul_f32 v11, v104, v11
    s_waitcnt lgkmcnt(7)
    v_mfma_f32_32x32x16_bf16 v[16:31], a[88:91], v[48:51], v[16:31]
    ds_read_b128 v[48:51], v106 offset:7168
    v_mul_f32 v12, v104, v12
    v_mul_f32 v13, v104, v13
    v_mul_f32 v14, v104, v14
    s_waitcnt lgkmcnt(7)
    v_mfma_f32_32x32x16_bf16 v[16:31], a[96:99], v[52:55], v[16:31]
    ds_read_b128 v[52:55], v106 offset:15360
    v_mul_f32 v15, v104, v15
    v_cvt_pk_bf16_f32 v0, v0, v1
    v_cvt_pk_bf16_f32 v1, v2, v3
    s_waitcnt lgkmcnt(7)
    v_mfma_f32_32x32x16_bf16 v[16:31], a[100:103], v[56:59], v[16:31]
    ds_read_b128 v[56:59], v106 offset:23552
    v_cvt_pk_bf16_f32 v2, v4, v5
    v_cvt_pk_bf16_f32 v3, v6, v7
    v_cvt_pk_bf16_f32 v4, v8, v9
    s_waitcnt lgkmcnt(7)
    v_mfma_f32_32x32x16_bf16 v[16:31], a[104:107], v[60:63], v[16:31]
    ds_read_b128 v[60:63], v106 offset:31744
    v_cvt_pk_bf16_f32 v5, v10, v11
    v_cvt_pk_bf16_f32 v6, v12, v13
    v_cvt_pk_bf16_f32 v7, v14, v15
    s_waitcnt lgkmcnt(7)
    v_mfma_f32_32x32x16_bf16 v[16:31], a[108:111], v[32:35], v[16:31]
    s_add_u32 s43, s43, s46
    s_cmp_eq_u32 s43, 0x18000
    s_cselect_b32 s44, 0xffff0000, s46
    s_cselect_b32 s43, 0, s43
    v_add_u32 v106, s44, v106
    ds_read_b128 v[32:35], v106 offset:0
    ds_write_b64 v110, v[0:1] offset:0
    ds_write_b64 v110, v[2:3] offset:16
    ds_write_b64 v110, v[4:5] offset:32
    s_waitcnt lgkmcnt(10)
    v_mfma_f32_32x32x16_bf16 v[16:31], a[112:115], v[36:39], v[16:31]
    ds_read_b128 v[36:39], v106 offset:1024
    ds_write_b64 v110, v[6:7] offset:48
    ds_read_b128 v[8:11], v111 offset:0
    ds_read_b128 v[12:15], v111 offset:1280
    s_waitcnt lgkmcnt(13)
    v_mfma_f32_32x32x16_bf16 v[16:31], a[116:119], v[40:43], v[16:31]
    ds_read_b128 v[40:43], v106 offset:2048
    s_add_u32 s45, s38, 4096
    s_waitcnt lgkmcnt(2)
    buffer_store_dwordx4 v[8:11], v108, s[24:27], s38 offen offset:0 nt
    s_waitcnt lgkmcnt(1)
    buffer_store_dwordx4 v[12:15], v108, s[24:27], s45 offen offset:0 nt
    v_mfma_f32_32x32x16_bf16 v[16:31], a[120:123], v[44:47], v[16:31]
    ds_read_b128 v[44:47], v106 offset:3072
    s_add_u32 s38, s38, 8192
    v_mfma_f32_32x32x16_bf16 v[16:31], a[28:31], v[48:51], v[16:31]
    ds_read_b128 v[48:51], v106 offset:4096
    v_mfma_f32_32x32x16_bf16 v[16:31], a[60:63], v[52:55], v[16:31]
    ds_read_b128 v[52:55], v106 offset:5120
    v_mfma_f32_32x32x16_bf16 v[16:31], a[92:95], v[56:59], v[16:31]
    ds_read_b128 v[56:59], v106 offset:6144
    v_mfma_f32_32x32x16_bf16 v[16:31], a[124:127], v[60:63], v[16:31]
    ds_read_b128 v[60:63], v106 offset:8192
    v_mfma_f32_32x32x16_bf16 v[0:15], a[0:3], v[32:35], 0
    ds_read_b128 v[32:35], v106 offset:9216
    ds_read_b128 v[96:99], v107 offset:1024
    ds_read_b128 v[100:103], v107 offset:1040
    v_mfma_f32_32x32x16_bf16 v[0:15], a[4:7], v[36:39], v[0:15]
    ds_read_b128 v[36:39], v106 offset:10240
    s_waitcnt lgkmcnt(2)
    v_add_f32 v96, v96, v97
    v_add_f32 v98, v98, v99
    v_mfma_f32_32x32x16_bf16 v[0:15], a[8:11], v[40:43], v[0:15]
    ds_read_b128 v[40:43], v106 offset:11264
    s_waitcnt lgkmcnt(2)
    v_add_f32 v100, v100, v101
    v_add_f32 v102, v102, v103
    v_mfma_f32_32x32x16_bf16 v[0:15], a[12:15], v[44:47], v[0:15]
    ds_read_b128 v[44:47], v106 offset:12288
    v_add_f32 v96, v96, v98
    v_add_f32 v100, v100, v102
    v_mfma_f32_32x32x16_bf16 v[0:15], a[16:19], v[48:51], v[0:15]
    ds_read_b128 v[48:51], v106 offset:13312
    v_add_f32 v96, v96, v100
    v_rcp_f32 v105, v96
    v_mfma_f32_32x32x16_bf16 v[0:15], a[20:23], v[52:55], v[0:15]
    ds_read_b128 v[52:55], v106 offset:14336
    s_add_u32 m0, s37, s36
    s_add_u32 s32, s37, s36
    v_mfma_f32_32x32x16_bf16 v[0:15], a[24:27], v[56:59], v[0:15]
    ds_read_b128 v[56:59], v106 offset:16384
    buffer_load_dwordx4 v109, s[12:15], s39 offen offset:0 nt lds
    s_add_u32 m0, s32, 960
    v_mfma_f32_32x32x16_bf16 v[0:15], a[32:35], v[60:63], v[0:15]
    ds_read_b128 v[60:63], v106 offset:17408
    s_add_u32 s33, s36, 8192
    buffer_load_dwordx4 v109, s[12:15], s39 offen offset:64 nt lds
    v_mfma_f32_32x32x16_bf16 v[0:15], a[36:39], v[32:35], v[0:15]
    ds_read_b128 v[32:35], v106 offset:18432
    s_add_u32 s39, s39, 8192
    s_and_b32 s36, s33, 0x7fff
    s_waitcnt lgkmcnt(7)
    v_mfma_f32_32x32x16_bf16 v[0:15], a[40:43], v[36:39], v[0:15]
    ds_read_b128 v[36:39], v106 offset:19456
    s_waitcnt lgkmcnt(7)
    v_mfma_f32_32x32x16_bf16 v[0:15], a[44:47], v[40:43], v[0:15]
    ds_read_b128 v[40:43], v106 offset:20480
    s_waitcnt lgkmcnt(7)
    v_mfma_f32_32x32x16_bf16 v[0:15], a[48:51], v[44:47], v[0:15]
    ds_read_b128 v[44:47], v106 offset:21504
    s_waitcnt lgkmcnt(7)
    v_mfma_f32_32x32x16_bf16 v[0:15], a[52:55], v[48:51], v[0:15]
    ds_read_b128 v[48:51], v106 offset:22528
    s_waitcnt lgkmcnt(7)
    v_mfma_f32_32x32x16_bf16 v[0:15], a[56:59], v[52:55], v[0:15]
    ds_read_b128 v[52:55], v106 offset:24576
    s_waitcnt lgkmcnt(7)
    v_mfma_f32_32x32x16_bf16 v[0:15], a[64:67], v[56:59], v[0:15]
    ds_read_b128 v[56:59], v106 offset:25600
    s_waitcnt lgkmcnt(7)
    v_mfma_f32_32x32x16_bf16 v[0:15], a[68:71], v[60:63], v[0:15]
    ds_read_b128 v[60:63], v106 offset:26624
    s_waitcnt vmcnt(2)
    s_nop 0
    s_barrier
    s_waitcnt lgkmcnt(7)
    v_mfma_f32_32x32x16_bf16 v[0:15], a[72:75], v[32:35], v[0:15]
    ds_read_b128 v[32:35], v106 offset:27648
    v_mul_f32 v16, v105, v16
    v_mul_f32 v17, v105, v17
    v_mul_f32 v18, v105, v18
    s_waitcnt lgkmcnt(7)
    v_mfma_f32_32x32x16_bf16 v[0:15], a[76:79], v[36:39], v[0:15]
    ds_read_b128 v[36:39], v106 offset:28672
    v_mul_f32 v19, v105, v19
    v_mul_f32 v20, v105, v20
    v_mul_f32 v21, v105, v21
    s_waitcnt lgkmcnt(7)
    v_mfma_f32_32x32x16_bf16 v[0:15], a[80:83], v[40:43], v[0:15]
    ds_read_b128 v[40:43], v106 offset:29696
    v_mul_f32 v22, v105, v22
    v_mul_f32 v23, v105, v23
    v_mul_f32 v24, v105, v24
    s_waitcnt lgkmcnt(7)
    v_mfma_f32_32x32x16_bf16 v[0:15], a[84:87], v[44:47], v[0:15]
    ds_read_b128 v[44:47], v106 offset:30720
    v_mul_f32 v25, v105, v25
    v_mul_f32 v26, v105, v26
    v_mul_f32 v27, v105, v27
    s_waitcnt lgkmcnt(7)
    v_mfma_f32_32x32x16_bf16 v[0:15], a[88:91], v[48:51], v[0:15]
    ds_read_b128 v[48:51], v106 offset:7168
    v_mul_f32 v28, v105, v28
    v_mul_f32 v29, v105, v29
    v_mul_f32 v30, v105, v30
    s_waitcnt lgkmcnt(7)
    v_mfma_f32_32x32x16_bf16 v[0:15], a[96:99], v[52:55], v[0:15]
    ds_read_b128 v[52:55], v106 offset:15360
    v_mul_f32 v31, v105, v31
    v_cvt_pk_bf16_f32 v16, v16, v17
    v_cvt_pk_bf16_f32 v17, v18, v19
    s_waitcnt lgkmcnt(7)
    v_mfma_f32_32x32x16_bf16 v[0:15], a[100:103], v[56:59], v[0:15]
    ds_read_b128 v[56:59], v106 offset:23552
    v_cvt_pk_bf16_f32 v18, v20, v21
    v_cvt_pk_bf16_f32 v19, v22, v23
    v_cvt_pk_bf16_f32 v20, v24, v25
    s_waitcnt lgkmcnt(7)
    v_mfma_f32_32x32x16_bf16 v[0:15], a[104:107], v[60:63], v[0:15]
    ds_read_b128 v[60:63], v106 offset:31744
    v_cvt_pk_bf16_f32 v21, v26, v27
    v_cvt_pk_bf16_f32 v22, v28, v29
    v_cvt_pk_bf16_f32 v23, v30, v31
    s_waitcnt lgkmcnt(7)
    v_mfma_f32_32x32x16_bf16 v[0:15], a[108:111], v[32:35], v[0:15]
    s_add_u32 s43, s43, s46
    s_cmp_eq_u32 s43, 0x18000
    s_cselect_b32 s44, 0xffff0000, s46
    s_cselect_b32 s43, 0, s43
    v_add_u32 v106, s44, v106
    ds_read_b128 v[32:35], v106 offset:0
    ds_write_b64 v110, v[16:17] offset:0
    ds_write_b64 v110, v[18:19] offset:16
    ds_write_b64 v110, v[20:21] offset:32
    s_waitcnt lgkmcnt(10)
    v_mfma_f32_32x32x16_bf16 v[0:15], a[112:115], v[36:39], v[0:15]
    ds_read_b128 v[36:39], v106 offset:1024
    ds_write_b64 v110, v[22:23] offset:48
    ds_read_b128 v[24:27], v111 offset:0
    ds_read_b128 v[28:31], v111 offset:1280
    s_waitcnt lgkmcnt(13)
    v_mfma_f32_32x32x16_bf16 v[0:15], a[116:119], v[40:43], v[0:15]
    ds_read_b128 v[40:43], v106 offset:2048
    s_add_u32 s45, s38, 4096
    s_waitcnt lgkmcnt(2)
    buffer_store_dwordx4 v[24:27], v108, s[24:27], s38 offen offset:0 nt
    s_waitcnt lgkmcnt(1)
    buffer_store_dwordx4 v[28:31], v108, s[24:27], s45 offen offset:0 nt
    v_mfma_f32_32x32x16_bf16 v[0:15], a[120:123], v[44:47], v[0:15]
    ds_read_b128 v[44:47], v106 offset:3072
    s_add_u32 s38, s38, 8192
    v_mfma_f32_32x32x16_bf16 v[0:15], a[28:31], v[48:51], v[0:15]
    ds_read_b128 v[48:51], v106 offset:4096
    v_mfma_f32_32x32x16_bf16 v[0:15], a[60:63], v[52:55], v[0:15]
    ds_read_b128 v[52:55], v106 offset:5120
    v_mfma_f32_32x32x16_bf16 v[0:15], a[92:95], v[56:59], v[0:15]
    ds_read_b128 v[56:59], v106 offset:6144
    v_mfma_f32_32x32x16_bf16 v[0:15], a[124:127], v[60:63], v[0:15]
    ds_read_b128 v[60:63], v106 offset:8192
    v_mfma_f32_32x32x16_bf16 v[16:31], a[0:3], v[32:35], 0
    ds_read_b128 v[32:35], v106 offset:9216
    ds_read_b128 v[96:99], v107 offset:0
    ds_read_b128 v[100:103], v107 offset:16
    v_mfma_f32_32x32x16_bf16 v[16:31], a[4:7], v[36:39], v[16:31]
    ds_read_b128 v[36:39], v106 offset:10240
    s_waitcnt lgkmcnt(2)
    v_add_f32 v96, v96, v97
    v_add_f32 v98, v98, v99
    v_mfma_f32_32x32x16_bf16 v[16:31], a[8:11], v[40:43], v[16:31]
    ds_read_b128 v[40:43], v106 offset:11264
    s_waitcnt lgkmcnt(2)
    v_add_f32 v100, v100, v101
    v_add_f32 v102, v102, v103
    v_mfma_f32_32x32x16_bf16 v[16:31], a[12:15], v[44:47], v[16:31]
    ds_read_b128 v[44:47], v106 offset:12288
    v_add_f32 v96, v96, v98
    v_add_f32 v100, v100, v102
    v_mfma_f32_32x32x16_bf16 v[16:31], a[16:19], v[48:51], v[16:31]
    ds_read_b128 v[48:51], v106 offset:13312
    v_add_f32 v96, v96, v100
    v_rcp_f32 v104, v96
    v_mfma_f32_32x32x16_bf16 v[16:31], a[20:23], v[52:55], v[16:31]
    ds_read_b128 v[52:55], v106 offset:14336
    s_add_u32 m0, s37, s36
    s_add_u32 s32, s37, s36
    v_mfma_f32_32x32x16_bf16 v[16:31], a[24:27], v[56:59], v[16:31]
    ds_read_b128 v[56:59], v106 offset:16384
    buffer_load_dwordx4 v109, s[12:15], s39 offen offset:0 nt lds
    s_add_u32 m0, s32, 960
    v_mfma_f32_32x32x16_bf16 v[16:31], a[32:35], v[60:63], v[16:31]
    ds_read_b128 v[60:63], v106 offset:17408
    s_add_u32 s33, s36, 8192
    buffer_load_dwordx4 v109, s[12:15], s39 offen offset:64 nt lds
    v_mfma_f32_32x32x16_bf16 v[16:31], a[36:39], v[32:35], v[16:31]
    ds_read_b128 v[32:35], v106 offset:18432
    s_add_u32 s39, s39, 8192
    s_and_b32 s36, s33, 0x7fff
    s_waitcnt lgkmcnt(7)
    v_mfma_f32_32x32x16_bf16 v[16:31], a[40:43], v[36:39], v[16:31]
    ds_read_b128 v[36:39], v106 offset:19456
    s_waitcnt lgkmcnt(7)
    v_mfma_f32_32x32x16_bf16 v[16:31], a[44:47], v[40:43], v[16:31]
    ds_read_b128 v[40:43], v106 offset:20480
    s_waitcnt lgkmcnt(7)
    v_mfma_f32_32x32x16_bf16 v[16:31], a[48:51], v[44:47], v[16:31]
    ds_read_b128 v[44:47], v106 offset:21504
    s_waitcnt lgkmcnt(7)
    v_mfma_f32_32x32x16_bf16 v[16:31], a[52:55], v[48:51], v[16:31]
    ds_read_b128 v[48:51], v106 offset:22528
    s_waitcnt lgkmcnt(7)
    v_mfma_f32_32x32x16_bf16 v[16:31], a[56:59], v[52:55], v[16:31]
    ds_read_b128 v[52:55], v106 offset:24576
    s_waitcnt lgkmcnt(7)
    v_mfma_f32_32x32x16_bf16 v[16:31], a[64:67], v[56:59], v[16:31]
    ds_read_b128 v[56:59], v106 offset:25600
    s_waitcnt lgkmcnt(7)
    v_mfma_f32_32x32x16_bf16 v[16:31], a[68:71], v[60:63], v[16:31]
    ds_read_b128 v[60:63], v106 offset:26624
    s_waitcnt vmcnt(2)
    s_nop 0
    s_barrier
    s_sub_u32 s31, s31, 1
    s_cmp_lg_u32 s31, 0
    s_cbranch_scc1 L_cloop
    s_waitcnt lgkmcnt(7)
    v_mfma_f32_32x32x16_bf16 v[16:31], a[72:75], v[32:35], v[16:31]
    ds_read_b128 v[32:35], v106 offset:27648
    ds_read_b128 v[96:99], v107 offset:1024
    ds_read_b128 v[100:103], v107 offset:1040
    s_waitcnt lgkmcnt(1)
    v_add_f32 v96, v96, v97
    v_mfma_f32_32x32x16_bf16 v[16:31], a[76:79], v[36:39], v[16:31]
    ds_read_b128 v[36:39], v106 offset:28672
    v_add_f32 v98, v98, v99
    s_waitcnt lgkmcnt(1)
    v_add_f32 v100, v100, v101
    v_add_f32 v102, v102, v103
    v_mfma_f32_32x32x16_bf16 v[16:31], a[80:83], v[40:43], v[16:31]
    ds_read_b128 v[40:43], v106 offset:29696
    v_add_f32 v96, v96, v98
    v_add_f32 v100, v100, v102
    v_add_f32 v96, v96, v100
    v_mfma_f32_32x32x16_bf16 v[16:31], a[84:87], v[44:47], v[16:31]
    ds_read_b128 v[44:47], v106 offset:30720
    v_rcp_f32 v105, v96
    v_mul_f32 v0, v104, v0
    v_mul_f32 v1, v104, v1
    v_mfma_f32_32x32x16_bf16 v[16:31], a[88:91], v[48:51], v[16:31]
    ds_read_b128 v[48:51], v106 offset:7168
    v_mul_f32 v2, v104, v2
    v_mul_f32 v3, v104, v3
    v_mul_f32 v4, v104, v4
    v_mfma_f32_32x32x16_bf16 v[16:31], a[96:99], v[52:55], v[16:31]
    ds_read_b128 v[52:55], v106 offset:15360
    v_mul_f32 v5, v104, v5
    v_mul_f32 v6, v104, v6
    v_mul_f32 v7, v104, v7
    v_mfma_f32_32x32x16_bf16 v[16:31], a[100:103], v[56:59], v[16:31]
    ds_read_b128 v[56:59], v106 offset:23552
    v_mul_f32 v8, v104, v8
    v_mul_f32 v9, v104, v9
    v_mul_f32 v10, v104, v10
    v_mfma_f32_32x32x16_bf16 v[16:31], a[104:107], v[60:63], v[16:31]
    ds_read_b128 v[60:63], v106 offset:31744
    v_mul_f32 v11, v104, v11
    v_mul_f32 v12, v104, v12
    v_mul_f32 v13, v104, v13
    v_mfma_f32_32x32x16_bf16 v[16:31], a[108:111], v[32:35], v[16:31]
    v_mul_f32 v14, v104, v14
    v_mul_f32 v15, v104, v15
    v_cvt_pk_bf16_f32 v0, v0, v1
    s_waitcnt lgkmcnt(6)
    v_mfma_f32_32x32x16_bf16 v[16:31], a[112:115], v[36:39], v[16:31]
    v_cvt_pk_bf16_f32 v1, v2, v3
    v_cvt_pk_bf16_f32 v2, v4, v5
    v_cvt_pk_bf16_f32 v3, v6, v7
    s_waitcnt lgkmcnt(5)
    v_mfma_f32_32x32x16_bf16 v[16:31], a[116:119], v[40:43], v[16:31]
    v_cvt_pk_bf16_f32 v4, v8, v9
    v_cvt_pk_bf16_f32 v5, v10, v11
    v_cvt_pk_bf16_f32 v6, v12, v13
    s_waitcnt lgkmcnt(4)
    v_mfma_f32_32x32x16_bf16 v[16:31], a[120:123], v[44:47], v[16:31]
    v_cvt_pk_bf16_f32 v7, v14, v15
    ds_write_b64 v110, v[0:1] offset:0
    ds_write_b64 v110, v[2:3] offset:16
    s_waitcnt lgkmcnt(5)
    v_mfma_f32_32x32x16_bf16 v[16:31], a[28:31], v[48:51], v[16:31]
    ds_write_b64 v110, v[4:5] offset:32
    ds_write_b64 v110, v[6:7] offset:48
    ds_read_b128 v[8:11], v111 offset:0
    s_waitcnt lgkmcnt(7)
    v_mfma_f32_32x32x16_bf16 v[16:31], a[60:63], v[52:55], v[16:31]
    ds_read_b128 v[12:15], v111 offset:1280
    s_add_u32 s45, s38, 4096
    s_waitcnt lgkmcnt(1)
    buffer_store_dwordx4 v[8:11], v108, s[24:27], s38 offen offset:0 nt
    v_mfma_f32_32x32x16_bf16 v[16:31], a[92:95], v[56:59], v[16:31]
    s_waitcnt lgkmcnt(0)
    buffer_store_dwordx4 v[12:15], v108, s[24:27], s45 offen offset:0 nt
    s_add_u32 s38, s38, 8192
    v_mfma_f32_32x32x16_bf16 v[16:31], a[124:127], v[60:63], v[16:31]
    s_nop 11
    v_mul_f32 v16, v105, v16
    v_mul_f32 v17, v105, v17
    v_mul_f32 v18, v105, v18
    v_mul_f32 v19, v105, v19
    v_mul_f32 v20, v105, v20
    v_mul_f32 v21, v105, v21
    v_mul_f32 v22, v105, v22
    v_mul_f32 v23, v105, v23
    v_mul_f32 v24, v105, v24
    v_mul_f32 v25, v105, v25
    v_mul_f32 v26, v105, v26
    v_mul_f32 v27, v105, v27
    v_mul_f32 v28, v105, v28
    v_mul_f32 v29, v105, v29
    v_mul_f32 v30, v105, v30
    v_mul_f32 v31, v105, v31
    v_cvt_pk_bf16_f32 v16, v16, v17
    v_cvt_pk_bf16_f32 v17, v18, v19
    v_cvt_pk_bf16_f32 v18, v20, v21
    v_cvt_pk_bf16_f32 v19, v22, v23
    v_cvt_pk_bf16_f32 v20, v24, v25
    v_cvt_pk_bf16_f32 v21, v26, v27
    v_cvt_pk_bf16_f32 v22, v28, v29
    v_cvt_pk_bf16_f32 v23, v30, v31
    ds_write_b64 v110, v[16:17] offset:0
    ds_write_b64 v110, v[18:19] offset:16
    ds_write_b64 v110, v[20:21] offset:32
    ds_write_b64 v110, v[22:23] offset:48
    ds_read_b128 v[24:27], v111 offset:0
    ds_read_b128 v[28:31], v111 offset:1280
    s_add_u32 s45, s38, 4096
    s_waitcnt lgkmcnt(1)
    buffer_store_dwordx4 v[24:27], v108, s[24:27], s38 offen offset:0 nt
    s_waitcnt lgkmcnt(0)
    buffer_store_dwordx4 v[28:31], v108, s[24:27], s45 offen offset:0 nt
    s_add_u32 s38, s38, 8192
    s_endpgm
L_end:
    s_endpgm
.section .rodata,"a"
.p2align 6
.amdhsa_kernel standalone__gqa_softmax__near_ridge_kernel
  .amdhsa_next_free_vgpr 256
  .amdhsa_next_free_sgpr 64
  .amdhsa_accum_offset 128
  .amdhsa_group_segment_fixed_size 0
  .amdhsa_kernarg_size 48
  .amdhsa_user_sgpr_count 2
  .amdhsa_user_sgpr_kernarg_segment_ptr 1
  .amdhsa_system_sgpr_workgroup_id_x 1
.end_amdhsa_kernel
```
